```python
import torch

def _softmax(x, axis=-1):
    return torch.softmax(x, dim=axis)
def _gelu(x):
    return torch.nn.functional.gelu(x, approximate="tanh")
def _silu(x):
    return torch.nn.functional.silu(x)
def _sigmoid(x):
    return torch.sigmoid(x)
def _layernorm(x, axis=-1, eps=1e-5):
    m = x.mean(dim=axis, keepdim=True)
    v = x.var(dim=axis, keepdim=True, unbiased=False)
    return (x - m) / torch.sqrt(v + eps)
def _scatter_add(tgt, idx, src, axis=0):
    return tgt.clone().index_add_(axis, idx, src)
def _segment_sum(src, seg, n):
    out = torch.zeros((n,) + src.shape[1:], dtype=src.dtype)
    return out.index_add_(0, seg, src)
def _pad(x, pw):
    flat = tuple(v for pair in reversed(pw) for v in pair)
    return torch.nn.functional.pad(x, flat)

kernel_name = 'sequential_preLN__sliding_block_cached__glu_gated_geglu__decode'

def setup_inputs():

    _w = (lambda a: (lambda t: t.to(torch.bfloat16) if t.is_floating_point() else t)(torch.as_tensor(a)))
    def _A_setup():
        B, Sq, D = 1, 1, 576
        Hq, Hkv, Sk, Dh = 32, 16, 8192, 128
        assert Hq % Hkv == 0, (Hq, Hkv)
        return {
            "x": _w((lambda *s: torch.randn(*s, dtype=torch.bfloat16) * 0.05)(B, Sq, D)),
            "k_cache": _w((lambda *s: torch.randn(*s, dtype=torch.bfloat16) * 1.6)(B, Hkv, Sk, Dh)),
            "v_cache": _w((lambda *s: torch.randn(*s, dtype=torch.bfloat16) * 0.8)(B, Hkv, Sk, Dh)),
            "wq": _w((lambda *s: torch.randn(*s, dtype=torch.bfloat16) * 1.6)(D, Hq * Dh) * (D ** -0.5)),
            "wo": _w((lambda *s: torch.randn(*s, dtype=torch.bfloat16) * 0.8)(Hq * Dh, D) * ((Hq * Dh) ** -0.5)),
        }
    _A_in = _A_setup()

    def _B_setup():
        B, S, Dm, Df = 1, 1, 576, 4608
        return {
            "x": _w((lambda *s: torch.randn(*s, dtype=torch.bfloat16) * 0.05)(B, S, Dm)),
            "w_gate": _w((lambda *s: torch.randn(*s, dtype=torch.bfloat16) * 0.4)(Dm, Df) * (Dm ** -0.5)),
            "w_up": _w((lambda *s: torch.randn(*s, dtype=torch.bfloat16) * 0.4)(Dm, Df) * (Dm ** -0.5)),
            "w_down": _w((lambda *s: torch.randn(*s, dtype=torch.bfloat16) * 0.4)(Df, Dm) * (Df ** -0.5)),
        }
    _B_in = _B_setup()

    return {
        "A_x": _A_in["x"],
        "A_k_cache": _A_in["k_cache"],
        "A_v_cache": _A_in["v_cache"],
        "A_wq": _A_in["wq"],
        "A_wo": _A_in["wo"],
        "B_x": _B_in["x"],
        "B_w_gate": _B_in["w_gate"],
        "B_w_up": _B_in["w_up"],
        "B_w_down": _B_in["w_down"],
    }

def reference(A_x, A_k_cache, A_v_cache, A_wq, A_wo, B_x, B_w_gate, B_w_up, B_w_down):
    def _A_ref(x, k_cache, v_cache, wq, wo):
        B, Sq, D = x.shape
        Hq, Dh = 32, 128
        Hkv, Sk = k_cache.shape[1], k_cache.shape[2]
        W = min(4096, max(256, Sk // 4))
        rep = Hq // Hkv
        q = (lambda x, *d: x.permute(*d))((x @ wq).reshape(B, Sq, Hq, Dh), 0, 2, 1, 3)
        k = (lambda x, n, axis: torch.repeat_interleave(x, n, dim=axis))(k_cache[:, :, Sk - W:, :], rep, axis=1)
        v = (lambda x, n, axis: torch.repeat_interleave(x, n, dim=axis))(v_cache[:, :, Sk - W:, :], rep, axis=1)
        scores = torch.einsum("bhqd,bhkd->bhqk", q, k) * (Dh ** -0.5)
        p = _softmax(scores, axis=-1)
        o = torch.einsum("bhqk,bhkd->bhqd", p, v)
        return (lambda x, *d: x.permute(*d))(o, 0, 2, 1, 3).reshape(B, Sq, Hq * Dh) @ wo

    def _B_ref(x, w_gate, w_up, w_down):
        g = torch.einsum("bsd,df->bsf", x, w_gate)
        u = torch.einsum("bsd,df->bsf", x, w_up)
        h = _gelu(g) * u
        return torch.einsum("bsf,fd->bsd", h, w_down)

    x = A_x
    h = x + _A_ref(_layernorm(x, axis=-1), A_k_cache, A_v_cache, A_wq, A_wo)
    h2 = h + _B_ref(_layernorm(h, axis=-1), B_w_gate, B_w_up, B_w_down)
    return h2
```

```asm
; @launch grid=(256,1,1) block=(576,1,1) lds=140544
.amdgcn_target "amdgcn-amd-amdhsa--gfx950"
.text
.globl sequential_preLN__sliding_block_cached__glu_gated_geglu__decode_kernel
.p2align 8
.type sequential_preLN__sliding_block_cached__glu_gated_geglu__decode_kernel,@function
sequential_preLN__sliding_block_cached__glu_gated_geglu__decode_kernel:
L_code_start:
s_load_dwordx16 s[4:19], s[0:1], 0
s_load_dwordx8 s[20:27], s[0:1], 64
v_readfirstlane_b32 s28, v0
s_cmpk_ge_u32 s2, 256
s_cbranch_scc1 L_end
s_lshr_b32 s28, s28, 6
s_cbranch_scc1 L_nql
s_getpc_b64 s[96:97]
v_lshlrev_b32 v12, 7, v0
global_load_dword v159, v12, s[96:97]
v_lshrrev_b32 v9, 3, v0
v_and_b32 v15, 6, v9
v_xor_b32 v11, v0, v15
v_and_b32 v11, 7, v11
v_lshlrev_b32 v11, 4, v11
v_lshl_add_u32 v15, v9, 13, v11
v_add_u32 v19, 64512, v15
v_lshlrev_b32 v16, 4, v0
s_lshr_b32 s41, s2, 6
s_mul_i32 s41, s41, 1178624
s_and_b32 s29, s2, 7
s_lshr_b32 s30, s2, 3
s_lshl3_add_u32 s42, s29, s30
s_lshl_b32 s42, s42, 7
s_add_u32 s54, s41, s42
s_movk_i32 s57, 512
s_xor_b32 s54, s54, s57
s_mov_b32 s46, 4718592
s_mov_b32 s47, 0x20000
s_mov_b32 m0, 110592
s_movk_i32 s41, 8
s_waitcnt lgkmcnt(0)
s_load_dword s34, s[26:27], 0
global_load_lds_dwordx4 v16, s[4:5]
s_bfm_b64 exec, 8, 0
global_load_lds_dwordx4 v16, s[4:5] offset:1024
s_mov_b64 exec, -1
s_mov_b64 s[44:45], s[10:11]
L_wq:
s_addk_i32 m0, 2048
s_cmp_eq_u32 s41, 5
buffer_load_dwordx4 v15, s[44:47], s54 offen nt lds
buffer_load_dwordx4 v19, s[44:47], s54 offen offset:1024 nt lds
s_cselect_b32 s42, s57, 0
s_xor_b32 s54, s54, s42
s_add_u32 s54, s54, s47
s_sub_u32 s41, s41, 1
s_cbranch_scc0 L_wq
s_branch L_ql
.p2align 8
L_nql:
s_lshr_b32 s30, s2, 3
s_and_b32 s29, s2, 7
v_and_b32 v1, 63, v0
s_lshr_b32 s31, s30, 4
s_lshl1_add_u32 s32, s29, s31
s_and_b32 s33, s30, 15
v_lshrrev_b32 v3, 4, v1
v_and_b32 v5, 3, v1
s_sub_u32 s55, s28, 1
s_and_b32 s38, s55, 3
s_cmp_ge_u32 s28, 5
s_cbranch_scc1 L_idle
s_lshl_b32 s41, s32, 21
s_lshl_b32 s42, s33, 15
s_add_u32 s41, s41, s42
s_lshl_b32 s42, s55, 1
s_xor_b32 s42, s42, s33
s_and_b32 s42, s42, 7
s_lshl_b32 s42, s42, 12
s_add_u32 s41, s41, s42
s_lshr_b32 s42, s30, 3
s_lshl_b32 s42, s42, 10
s_add_u32 s41, s41, s42
s_add_u32 s41, s41, 1572864
v_bfe_u32 v9, v1, 2, 2
v_lshlrev_b32 v10, 8, v9
v_lshl_add_u32 v10, v3, 6, v10
v_lshl_add_u32 v10, v5, 4, v10
v_add_u32 v10, s41, v10
v_lshl_add_u32 v11, v1, 4, s41
v_xor_b32 v120, 4096, v10
v_xor_b32 v121, 4096, v11
s_waitcnt lgkmcnt(0)
s_barrier
global_load_dwordx4 v[16:19], v10, s[6:7] nt
v_xor_b32 v121, 1024, v10
global_load_dwordx4 v[20:23], v121, s[6:7] nt
v_xor_b32 v122, 2048, v10
global_load_dwordx4 v[24:27], v122, s[6:7] nt
v_xor_b32 v123, 3072, v10
global_load_dwordx4 v[28:31], v123, s[6:7] nt
v_xor_b32 v120, 4096, v10
global_load_dwordx4 v[32:35], v120, s[6:7] nt
v_xor_b32 v121, 5120, v10
global_load_dwordx4 v[36:39], v121, s[6:7] nt
s_branch L_att
L_idle:
s_cmp_eq_u32 s28, 8
s_cbranch_scc0 L_npf
s_getpc_b64 s[44:45]
L_pc:
v_lshlrev_b32 v12, 7, v1
v_add_u32 v12, 8192-(L_pc-L_code_start), v12
v_min_u32 v12, L_code_end-L_pc-4, v12
global_load_dword v159, v12, s[44:45]
L_npf:
s_lshl_b32 s41, s29, 5
s_add_u32 s41, s41, s30
s_cmp_eq_u32 s38, 1
s_cselect_b32 s42, 10, 9
s_mov_b32 s57, 4096
s_cselect_b32 s57, 139264, s57
s_cselect_b32 s58, 0xff, 15
s_cmp_eq_u32 s38, 2
s_cselect_b32 s42, 4, s42
s_cselect_b32 s57, 401408, s57
s_cselect_b32 s58, 1, s58
s_lshl_b32 s41, s41, s42
s_add_u32 s41, s41, s57
v_lshl_add_u32 v12, v1, 7, s41
s_cmp_ge_u32 s38, 3
s_waitcnt lgkmcnt(0)
s_cbranch_scc1 L_ntch
s_mov_b32 exec_lo, s58
s_mov_b32 exec_hi, 0
global_load_dword v158, v12, s[26:27] sc1
s_mov_b64 exec, -1
L_ntch:
s_waitcnt lgkmcnt(0)
s_load_dword s34, s[26:27], 0
v_and_b32 v4, 15, v1
v_mov_b32 v6, 137280
v_mov_b32 v7, 0xff
s_mov_b32 s43, 1048575
s_cmp_lt_u32 s30, 27
s_cselect_b32 s56, 1, 2
s_cmp_lt_u32 s30, 18
s_cselect_b32 s56, 0, s56
s_mul_i32 s52, s29, 18
s_add_u32 s52, s52, s30
s_sub_u32 s53, s30, 18
s_add_u32 s60, s26, 524288
s_addc_u32 s61, s27, 0
s_mov_b64 s[62:63], s[26:27]
v_lshlrev_b32 v12, 3, v0
v_mov_b32 v14, 0
v_mov_b32 v15, 0
v_add_u32 v12, 134912, v12
ds_write_b64 v12, v[14:15]
v_lshl_add_u32 v12, v4, 3, v6
ds_write_b64 v12, v[14:15]
v_lshlrev_b32 v12, 2, v0
v_add_u32 v12, 138240, v12
v_mov_b32 v13, 0x3f803f80
ds_write_b32 v12, v13
v_bfe_u32 v30, v1, 2, 3
v_lshrrev_b32 v32, 1, v5
v_lshl_add_u32 v32, s38, 1, v32
v_and_b32 v31, 6, v30
v_xor_b32 v32, v32, v31
v_lshlrev_b32 v32, 4, v32
v_lshl_add_u32 v32, v30, 7, v32
v_and_b32 v31, 1, v1
v_lshl_add_u32 v32, v31, 3, v32
v_lshrrev_b32 v31, 5, v1
v_lshl_add_u32 v32, v31, 11, v32
v_add_u32 v32, 112640, v32
v_lshlrev_b32 v36, 4, v3
s_and_b32 s41, s30, 7
s_lshl3_add_u32 s41, s29, s41
s_lshr_b32 s58, s30, 3
s_lshl3_add_u32 s41, s41, s58
s_lshl2_add_u32 s41, s41, s38
s_lshl_b32 s41, s41, 6
v_add_u32 v38, s41, v36
v_xor_b32 v12, 8192, v38
v_or_b32 v38, 1024, v38
v_cmp_eq_u32 vcc, 1, v4
    s_nop 1
v_cndmask_b32 v38, v12, v38, vcc
v_add_u32 v38, 4096, v38
v_add_u32 v36, 131072, v36
v_and_b32 v37, 1, v3
v_lshlrev_b32 v37, 4, v37
v_lshrrev_b32 v12, 5, v1
v_lshl_add_u32 v37, v12, 3, v37
v_add_u32 v37, 131328, v37
v_lshlrev_b32 v16, 4, v1
v_add_u32 v16, 110592, v16
v_lshlrev_b32 v18, 2, v1
v_add_u32 v18, 111616, v18
s_mul_i32 s58, s58, 288
s_add_u32 s58, s58, 110592
v_lshl_add_u32 v19, v1, 3, s58
v_and_b32 v17, 60, v1
v_and_b32 v13, 1, v1
v_lshl_add_u32 v17, v13, 1, v17
v_bfe_u32 v13, v1, 1, 1
v_add_lshl_u32 v17, v17, v13, 3
v_add_u32 v17, 131072, v17
v_lshlrev_b32 v12, 10, v12
v_sub_u32 v33, v32, v12
v_mov_b32 v25, 0x3f803f80
v_mov_b32 v24, 0
s_cmp_eq_u32 s28, 5
s_barrier
ds_read_b128 v[20:23], v16
ds_read_b64 v[28:29], v19
s_mov_b32 exec_hi, 0
ds_read_b32 v24, v18
s_mov_b32 exec_hi, -1
s_cbranch_scc0 L_nln
s_waitcnt lgkmcnt(0)
v_dot2_f32_bf16 v30, v20, v25, 0
v_dot2_f32_bf16 v31, v20, v20, 0
v_dot2_f32_bf16 v30, v21, v25, v30
v_dot2_f32_bf16 v31, v21, v21, v31
v_dot2_f32_bf16 v30, v22, v25, v30
v_dot2_f32_bf16 v31, v22, v22, v31
v_dot2_f32_bf16 v30, v23, v25, v30
v_dot2_f32_bf16 v31, v23, v23, v31
v_dot2_f32_bf16 v30, v24, v25, v30
v_dot2_f32_bf16 v31, v24, v24, v31
    s_nop 2
v_permlane32_swap_b32 v30, v31
v_add_f32 v30, v30, v31
    s_nop 1
v_add_f32_dpp v30, v30, v30 row_ror:1 row_mask:0xf bank_mask:0xf
    s_nop 1
v_add_f32_dpp v30, v30, v30 row_ror:2 row_mask:0xf bank_mask:0xf
    s_nop 1
v_add_f32_dpp v30, v30, v30 row_ror:4 row_mask:0xf bank_mask:0xf
    s_nop 1
v_add_f32_dpp v30, v30, v30 row_ror:8 row_mask:0xf bank_mask:0xf
    s_nop 1
v_permlane16_swap_b32 v30, v41
v_add_f32 v30, v30, v41
v_mul_f32 v30, 0x3ae38e39, v30
    s_nop 1
v_permlane32_swap_b32 v30, v31
v_fma_f32 v31, -v30, v30, v31
v_max_f32 v31, 0, v31
v_cvt_pk_bf16_f32 v41, v30, v31
v_and_b32 v31, 0xffff0000, v41
v_add_f32 v31, 0x3727c5ac, v31
v_cvt_pk_bf16_f32 v31, v31, v31
v_and_b32 v31, 0xffff0000, v31
v_sqrt_f32 v31, v31
v_lshlrev_b32 v30, 16, v41
v_cvt_pk_bf16_f32 v31, v31, v31
v_and_b32 v31, 0xffff0000, v31
v_rcp_f32 v31, v31
v_lshlrev_b32 v42, 16, v28
v_and_b32 v43, 0xffff0000, v28
v_readfirstlane_b32 s41, v30
v_readfirstlane_b32 s42, v31
v_lshlrev_b32 v44, 16, v29
v_and_b32 v45, 0xffff0000, v29
v_subrev_f32 v42, s41, v42
v_subrev_f32 v43, s41, v43
v_subrev_f32 v44, s41, v44
v_subrev_f32 v45, s41, v45
v_cvt_pk_bf16_f32 v28, v42, v43
v_cvt_pk_bf16_f32 v29, v44, v45
v_lshlrev_b32 v42, 16, v28
v_and_b32 v43, 0xffff0000, v28
v_lshlrev_b32 v44, 16, v29
v_and_b32 v45, 0xffff0000, v29
v_mul_f32 v42, s42, v42
v_mul_f32 v43, s42, v43
v_mul_f32 v44, s42, v44
v_mul_f32 v45, s42, v45
v_cvt_pk_bf16_f32 v28, v42, v43
v_cvt_pk_bf16_f32 v29, v44, v45
s_mov_b32 exec_hi, 0xf
ds_write_b64 v17, v[28:29]
s_mov_b32 exec_hi, -1
L_nln:
s_lshl2_add_u32 s41, s32, s38
s_lshl_b32 s41, s41, 11
s_add_u32 s41, s41, 4096
v_lshl_add_u32 v39, v1, 4, s41
s_lshl_b32 s41, s38, 7
s_add_u32 s41, s41, 131392
v_lshlrev_b32 v40, 3, v4
v_lshl_add_u32 v40, v3, 1, v40
v_add_u32 v40, s41, v40
v_lshl_add_u32 v34, s38, 2, v6
s_getreg_b32 s41, hwreg(HW_REG_XCC_ID, 0, 4)

v_mov_b32 v35, s41
s_waitcnt lgkmcnt(0)
s_add_u32 s34, s34, 1
s_and_b32 s35, s34, 0xff
s_mul_i32 s37, s35, 0x01010101
v_mov_b32 v2, s35
s_barrier
ds_read_b64_tr_b16 v[64:65], v32 offset:0
ds_read_b64_tr_b16 v[66:67], v32 offset:1024
ds_read_b128 v[44:47], v36 offset:0
ds_read_b64_tr_b16 v[68:69], v32 offset:4096
ds_read_b64_tr_b16 v[70:71], v32 offset:5120
ds_read_b128 v[48:51], v36 offset:64
ds_read_b64_tr_b16 v[72:73], v32 offset:8192
ds_read_b64_tr_b16 v[74:75], v32 offset:9216
ds_read_b128 v[52:55], v36 offset:128
ds_read_b64_tr_b16 v[76:77], v32 offset:12288
ds_read_b64_tr_b16 v[78:79], v32 offset:13312
ds_read_b128 v[56:59], v36 offset:192
ds_read_b64_tr_b16 v[80:81], v33 offset:16384
ds_read_b64 v[60:61], v37
s_waitcnt lgkmcnt(11)
v_mfma_f32_16x16x32_bf16 v[96:99], v[64:67], v[44:47], 0
s_waitcnt lgkmcnt(8)
v_mfma_f32_16x16x32_bf16 v[96:99], v[68:71], v[48:51], v[96:99]
s_waitcnt lgkmcnt(5)
v_mfma_f32_16x16x32_bf16 v[104:107], v[72:75], v[52:55], 0
s_waitcnt lgkmcnt(2)
v_mfma_f32_16x16x32_bf16 v[104:107], v[76:79], v[56:59], v[104:107]
s_waitcnt lgkmcnt(0)
v_mfma_f32_16x16x16_bf16 v[100:103], v[80:81], v[60:61], 0
s_mov_b32 exec_lo, 0x20002
s_mov_b32 exec_hi, 0x20002
    s_nop 5
v_pk_add_f32 v[96:97], v[104:105], v[100:101]
v_pk_add_f32 v[98:99], v[106:107], v[102:103]
s_mov_b32 exec_lo, 0x30003
s_mov_b32 exec_hi, 0x30003
v_bfi_b32 v96, v7, v2, v96
v_bfi_b32 v97, 15, v35, v97
global_store_dwordx4 v38, v[96:99], s[26:27]
s_mov_b64 exec, -1
s_mov_b32 s57, 0
s_setprio 3
s_barrier
s_barrier
global_load_dwordx4 v[64:67], v39, s[62:63] offset:0 sc1
global_load_dwordx4 v[68:71], v39, s[62:63] offset:1024 sc1
s_barrier
global_load_dwordx4 v[72:75], v39, s[62:63] offset:0 sc1
global_load_dwordx4 v[76:79], v39, s[62:63] offset:1024 sc1
s_barrier
global_load_dwordx4 v[80:83], v39, s[62:63] offset:0 sc1
global_load_dwordx4 v[84:87], v39, s[62:63] offset:1024 sc1
L_x_loop:
s_waitcnt vmcnt(4)
v_xor_b32 v64, v2, v64
v_xor_b32 v68, v2, v68
v_or_b32 v41, v64, v68
v_and_b32 v41, v7, v41
v_cmp_ne_u32 vcc, 0, v41
v_xor_b32 v104, v35, v65
v_xor_b32 v105, v35, v69
v_and_b32 v65, -16, v65
v_and_b32 v69, -16, v69
v_pk_add_f32 v[100:101], v[64:65], v[68:69]
v_pk_add_f32 v[102:103], v[66:67], v[70:71]
s_cbranch_vccz L_x_ok
global_load_dwordx4 v[64:67], v39, s[62:63] offset:0 sc1
global_load_dwordx4 v[68:71], v39, s[62:63] offset:1024 sc1
s_waitcnt vmcnt(4)
v_xor_b32 v72, v2, v72
v_xor_b32 v76, v2, v76
v_or_b32 v41, v72, v76
v_and_b32 v41, v7, v41
v_cmp_ne_u32 vcc, 0, v41
v_xor_b32 v104, v35, v73
v_xor_b32 v105, v35, v77
v_and_b32 v73, -16, v73
v_and_b32 v77, -16, v77
v_pk_add_f32 v[100:101], v[72:73], v[76:77]
v_pk_add_f32 v[102:103], v[74:75], v[78:79]
s_cbranch_vccz L_x_ok
global_load_dwordx4 v[72:75], v39, s[62:63] offset:0 sc1
global_load_dwordx4 v[76:79], v39, s[62:63] offset:1024 sc1
s_waitcnt vmcnt(4)
v_xor_b32 v80, v2, v80
v_xor_b32 v84, v2, v84
v_or_b32 v41, v80, v84
v_and_b32 v41, v7, v41
v_cmp_ne_u32 vcc, 0, v41
v_xor_b32 v104, v35, v81
v_xor_b32 v105, v35, v85
v_and_b32 v81, -16, v81
v_and_b32 v85, -16, v85
v_pk_add_f32 v[100:101], v[80:81], v[84:85]
v_pk_add_f32 v[102:103], v[82:83], v[86:87]
s_cbranch_vccz L_x_ok
s_and_b32 s41, s43, 1
s_cselect_b64 s[62:63], s[26:27], s[60:61]
global_load_dwordx4 v[80:83], v39, s[62:63] offset:0 sc1
global_load_dwordx4 v[84:87], v39, s[62:63] offset:1024 sc1
v_mov_b32 v41, 4
ds_write_b32 v34, v41 offset:32
s_cmp_lg_u32 s57, 0
s_cbranch_scc1 L_x_d1
s_mov_b32 s57, 1
s_mov_b32 exec_lo, 0x30003
s_mov_b32 exec_hi, 0x30003
global_store_dwordx4 v38, v[96:99], s[60:61] sc1
s_mov_b64 exec, -1
L_x_d1:
s_sub_u32 s43, s43, 1
s_cbranch_scc0 L_x_loop
s_mov_b32 s43, 0
L_x_ok:
v_or_b32 v104, v104, v105
v_and_b32 v104, 15, v104
v_cmp_ne_u32 vcc, 0, v104
v_permlane32_swap_b32 v100, v102
v_permlane32_swap_b32 v101, v103
v_pk_add_f32 v[100:101], v[100:101], v[102:103]
    s_nop 1
v_permlane16_swap_b32 v100, v101
v_add_f32 v100, v100, v101
s_cmp_eq_u64 vcc, 0
s_cselect_b32 s41, 2, 1
v_mov_b32 v41, s41
v_cvt_pk_bf16_f32 v100, v100, v100
ds_write_b16 v40, v100
ds_write_b32 v34, v41 offset:32
s_setprio 0
v_lshl_add_u32 v44, v5, 2, v6
L_x_w0:
ds_read_b32 v41, v44 offset:32
s_waitcnt lgkmcnt(0)
v_cmp_eq_u32 vcc, 0, v41
s_cbranch_vccz L_x_w1
s_sub_u32 s43, s43, 1
s_cbranch_scc0 L_x_w0
s_mov_b32 s43, 0
L_x_w1:
v_cmp_ne_u32 vcc, 2, v41
s_cbranch_vccz L_x_d2
s_cmp_lg_u32 s57, 0
s_cbranch_scc1 L_x_d2
s_mov_b32 s57, 1
s_mov_b32 exec_lo, 0x30003
s_mov_b32 exec_hi, 0x30003
global_store_dwordx4 v38, v[96:99], s[60:61] sc1
s_mov_b64 exec, -1
L_x_d2:
s_mov_b64 s[62:63], s[26:27]
s_cmp_eq_u32 s28, 5
s_cbranch_scc0 L_role
v_lshrrev_b32 v15, 3, v4
v_lshlrev_b32 v45, 5, v15
v_lshl_add_u32 v45, v5, 3, v45
v_add_u32 v45, 137344, v45
s_lshl_b32 s41, s32, 8
s_lshl3_add_u32 s41, s33, s41
s_add_u32 s41, s41, 401408
v_lshl_add_u32 v46, v15, 7, s41
v_mov_b32 v51, s37
v_lshlrev_b32 v42, 4, v1
v_add_u32 v42, 131904, v42
s_lshl_b32 s41, s29, 5
s_add_u32 s41, s41, s30
s_lshl_b32 s41, s41, 10
s_add_u32 s41, s41, 139264
v_and_b32 v43, 7, v1
v_lshlrev_b32 v43, 4, v43
v_lshl_add_u32 v43, v3, 7, v43
v_lshl_add_u32 v43, v15, 9, v43
v_add_u32 v43, s41, v43
v_lshl_add_u32 v44, v5, 2, v6
L_s_0:
ds_read_b64 v[48:49], v45
ds_read_b32 v47, v44 offset:32
s_waitcnt lgkmcnt(0)
v_cmp_eq_u32 vcc, 0, v49
s_cbranch_vccz L_s_1
s_sub_u32 s43, s43, 1
s_cbranch_scc0 L_s_0
s_mov_b32 s43, 0
L_s_1:
s_setprio 3
v_max_f32_dpp v52, v48, v48 quad_perm:[1,0,3,2] row_mask:0xf bank_mask:0xf
    s_nop 1
v_max_f32_dpp v52, v52, v52 quad_perm:[2,3,0,1] row_mask:0xf bank_mask:0xf
v_sub_f32 v48, v48, v52
v_exp_f32 v48, v48
    s_nop 0
v_mul_f32 v49, v48, v49
    s_nop 1
v_add_f32_dpp v49, v49, v49 quad_perm:[1,0,3,2] row_mask:0xf bank_mask:0xf
    s_nop 1
v_add_f32_dpp v49, v49, v49 quad_perm:[2,3,0,1] row_mask:0xf bank_mask:0xf
v_rcp_f32 v53, v49
v_log_f32 v50, v49
v_mul_f32 v48, v48, v53
v_add_f32 v50, v50, v52
    s_nop 0
v_mov_b32_dpp v54, v48 quad_perm:[0,0,0,0] row_mask:0xf bank_mask:0xf
v_mov_b32_dpp v56, v48 quad_perm:[1,1,1,1] row_mask:0xf bank_mask:0xf
v_mov_b32_dpp v58, v48 quad_perm:[2,2,2,2] row_mask:0xf bank_mask:0xf
v_mov_b32_dpp v60, v48 quad_perm:[3,3,3,3] row_mask:0xf bank_mask:0xf
v_cmp_ne_u32 vcc, 2, v47
    s_nop 0
s_cmp_eq_u64 vcc, 0
s_cselect_b32 s59, 1, 0
s_mov_b64 exec, 0x101
s_cmp_eq_u32 s59, 0
s_cbranch_scc1 L_ms1
global_store_dwordx2 v46, v[50:51], s[26:27]
s_branch L_me1
L_ms1:
global_store_dwordx2 v46, v[50:51], s[26:27] sc1
L_me1:
s_mov_b64 exec, -1
s_setprio 0
L_c0:
ds_read_b32 v41, v44 offset:48
ds_read_b128 v[16:19], v42 offset:0
ds_read_b128 v[20:23], v42 offset:1024
ds_read_b128 v[24:27], v42 offset:2048
ds_read_b128 v[28:31], v42 offset:3072
s_waitcnt lgkmcnt(4)
v_cmp_eq_u32 vcc, 0, v41
s_cbranch_vccz L_c1
s_sub_u32 s43, s43, 1
s_cbranch_scc0 L_c0
s_mov_b32 s43, 0
L_c1:
s_waitcnt lgkmcnt(3)
v_pk_mul_f32 v[16:17], v[16:17], v[54:55] op_sel_hi:[1,0]
v_pk_mul_f32 v[18:19], v[18:19], v[54:55] op_sel_hi:[1,0]
s_waitcnt lgkmcnt(2)
v_pk_fma_f32 v[16:17], v[20:21], v[56:57], v[16:17] op_sel_hi:[1,0,1]
v_pk_fma_f32 v[18:19], v[22:23], v[56:57], v[18:19] op_sel_hi:[1,0,1]
s_waitcnt lgkmcnt(1)
v_pk_fma_f32 v[16:17], v[24:25], v[58:59], v[16:17] op_sel_hi:[1,0,1]
v_pk_fma_f32 v[18:19], v[26:27], v[58:59], v[18:19] op_sel_hi:[1,0,1]
s_waitcnt lgkmcnt(0)
v_pk_fma_f32 v[16:17], v[28:29], v[60:61], v[16:17] op_sel_hi:[1,0,1]
v_pk_fma_f32 v[18:19], v[30:31], v[60:61], v[18:19] op_sel_hi:[1,0,1]
v_bfi_b32 v16, v7, v2, v16
s_cmp_eq_u32 s59, 0
s_cbranch_scc1 L_ms2
global_store_dwordx4 v43, v[16:19], s[26:27]
s_branch L_me2
L_ms2:
global_store_dwordx4 v43, v[16:19], s[26:27] sc1
L_me2:
ds_write_b32 v6, v7 offset:24
s_branch L_role
L_ql:
s_waitcnt vmcnt(18)
s_barrier
v_and_b32 v1, 63, v0
s_lshr_b32 s31, s30, 4
s_lshl1_add_u32 s32, s29, s31
s_and_b32 s33, s30, 15
v_lshrrev_b32 v3, 4, v1
v_and_b32 v5, 3, v1
v_lshrrev_b32 v8, 5, v1
v_bfe_u32 v9, v1, 3, 2
v_lshl_add_u32 v10, v8, 3, v9
v_and_b32 v4, 15, v1
v_mov_b32 v6, 137280
v_mov_b32 v7, 0xff
s_mov_b32 s43, 1048575
s_cmp_lt_u32 s30, 27
s_cselect_b32 s56, 1, 2
s_cmp_lt_u32 s30, 18
s_cselect_b32 s56, 0, s56
s_mul_i32 s52, s29, 18
s_add_u32 s52, s52, s30
s_sub_u32 s53, s30, 18
s_add_u32 s60, s26, 524288
s_addc_u32 s61, s27, 0
s_mov_b64 s[62:63], s[26:27]
v_mov_b32 v20, 0
v_mov_b32 v21, 0
v_mov_b32 v22, 0
v_mov_b32 v23, 0
v_mov_b32 v24, 0
v_mov_b32 v25, 0
v_mov_b32 v26, 0
v_mov_b32 v27, 0
s_mov_b32 s36, 0
s_cmp_eq_u32 s56, 0
s_cbranch_scc0 L_q_nF
s_mov_b32 s44, s16
s_and_b32 s45, s17, 0xffff
s_mov_b32 s46, 5308416
s_mov_b32 s47, 0x20000
s_mov_b32 s48, s18
s_and_b32 s49, s19, 0xffff
s_mov_b32 s50, 5308416
s_mov_b32 s51, 0x20000
s_mov_b32 s96, s20
s_and_b32 s97, s21, 0xffff
s_mov_b32 s98, 5308416
s_mov_b32 s99, 0x20000
s_and_b32 s41, s30, 1
s_mul_i32 s41, s41, 2654208
s_lshr_b32 s42, s52, 1
s_lshl_b32 s42, s42, 7
s_add_u32 s41, s41, s42
v_mul_u32_u24 v15, 9216, v10
v_add3_u32 v20, v15, v11, s41
v_add_u32 v21, 35840, v20
v_add_u32 v22, 145408, v20
v_add_u32 v23, 181248, v20
v_xor_b32 v24, 16, v20
v_xor_b32 v25, 16, v21
v_xor_b32 v26, 16, v22
v_xor_b32 v27, 16, v23
v_mov_b32 v12, 0
s_lshl_b32 s41, s52, 5
v_add_u32 v15, s41, v10
v_mul_u32_u24 v15, 1152, v15
v_add_u32 v16, v15, v11
v_add_u32 v17, 3584, v16
v_add_u32 v18, 16384, v16
v_add_u32 v19, 19968, v16
v_mov_b32 v14, 0
s_mov_b32 s39, 0
s_mov_b32 s40, 0
s_lshl_b32 s41, s28, 8
s_add_u32 s41, s41, 1048576
v_mul_u32_u24 v8, 2304, v3
v_lshl_add_u32 v8, v4, 4, v8
v_add_u32 v8, s41, v8
v_add_u32 v9, 9216, v8
s_lshl_b32 s41, s28, 7
v_lshlrev_b32 v10, 3, v4
v_lshl_add_u32 v10, v3, 1, v10
v_add_u32 v10, s41, v10
v_add_u32 v11, 110592, v10
ds_read_u16 v11, v11
v_add_u32 v10, 136000, v10
s_branch L_q_r
L_q_nF:
s_cmp_eq_u32 s56, 1
s_cbranch_scc0 L_q_nO
s_mov_b32 s44, s12
s_and_b32 s45, s13, 0xffff
s_mov_b32 s46, 4718592
s_mov_b32 s47, 0x20000
s_mov_b32 s48, s12
s_and_b32 s49, s13, 0xffff
s_mov_b32 s50, 4718592
s_mov_b32 s51, 0x20000
s_mov_b32 s96, s12
s_and_b32 s97, s13, 0xffff
s_mov_b32 s98, 4718592
s_mov_b32 s99, 0x20000
s_lshl_b32 s41, s29, 9
v_lshlrev_b32 v15, 3, v9
v_lshl_add_u32 v15, v8, 1, v15
v_add_u32 v15, s41, v15
v_mul_u32_u24 v15, 1152, v15
s_lshl_b32 s41, s53, 7
v_add3_u32 v16, v15, v11, s41
v_add_u32 v17, 128, v16
v_add_u32 v18, 2560, v16
v_add_u32 v19, 2688, v16
v_mov_b32 v12, 0
v_mov_b32 v13, 0
v_mov_b32 v14, 0
s_mov_b32 s39, 0
s_mov_b32 s40, 0
s_branch L_q_r
L_q_nO:
s_mov_b32 s44, s16
s_and_b32 s45, s17, 0xffff
s_mov_b32 s46, 5308416
s_mov_b32 s47, 0x20000
s_mov_b32 s48, s18
s_and_b32 s49, s19, 0xffff
s_mov_b32 s50, 5308416
s_mov_b32 s51, 0x20000
s_mov_b32 s96, s20
s_and_b32 s97, s21, 0xffff
s_mov_b32 s98, 5308416
s_mov_b32 s99, 0x20000
s_mul_i32 s41, s29, 9
s_sub_u32 s42, 3, s41
s_and_b32 s42, s42, 7
s_add_u32 s41, s41, s42
s_lshl_b32 s41, s41, 7
v_lshl_add_u32 v12, v8, 8, v1
v_add_u32 v12, 128, v12
v_mul_u32_u24 v12, 9216, v12
v_add_u32 v12, s41, v12
s_cmp_eq_u32 s42, 0
s_cselect_b32 s40, 10, 5
s_sub_u32 s39, s30, 27
s_xor_b32 s41, s29, 0
s_mul_i32 s41, s41, 663552
v_mul_u32_u24 v14, 1152, v1
v_add_u32 v14, s41, v14
v_mov_b32 v13, 0
v_mov_b32 v16, 0
v_mov_b32 v17, 0
v_mov_b32 v18, 0
v_mov_b32 v19, 0
L_q_r:
s_waitcnt lgkmcnt(0)
s_add_u32 s34, s34, 1
s_and_b32 s35, s34, 0xff
s_mul_i32 s37, s35, 0x01010101
v_mov_b32 v2, s35
s_waitcnt vmcnt(0)
s_barrier
s_sub_u32 s41, s30, 27
s_cmp_eq_u32 s56, 0
s_cselect_b32 s41, s30, s41
s_lshl_b32 s41, s41, 12
s_xor_b32 s42, s29, 0
s_mul_i32 s42, s42, 589824
s_add_u32 s41, s41, s42
s_add_u32 s41, s41, 147456
v_lshl_add_u32 v44, v1, 7, s41
s_mov_b32 s42, 0
s_mov_b32 s57, 0
s_mov_b32 s31, 0
s_barrier
s_barrier
s_barrier
s_barrier
s_cmp_ge_u32 s56, 1
s_cbranch_scc1 L_l_nF
s_mov_b64 exec, 0xff
s_movk_i32 s41, 5
L_tw:
global_load_dword v150, v44, s[12:13] offset:0
global_load_dword v151, v44, s[12:13] offset:1024
global_load_dword v152, v44, s[12:13] offset:2048
global_load_dword v153, v44, s[12:13] offset:3072
v_add_u32 v44, 73728, v44
s_sub_u32 s41, s41, 1
s_cbranch_scc0 L_tw
s_mov_b64 exec, -1
s_cmp_eq_u32 s56, 0
s_cbranch_scc0 L_l_nF
L_l_g:
s_mov_b32 m0, 0
s_mov_b32 s54, 0
s_movk_i32 s57, 8
s_cmp_lg_u32 s31, 0
s_cbranch_scc1 L_guu
L_gut:
s_waitcnt vmcnt(20)
ds_read_b32 v41, v6 offset:24
buffer_load_dwordx4 v20, s[44:47], s54 offen offset:0 nt lds
buffer_load_dwordx4 v21, s[44:47], s54 offen offset:1024 nt lds
buffer_load_dwordx4 v22, s[44:47], s54 offen offset:2048 nt lds
buffer_load_dwordx4 v23, s[44:47], s54 offen offset:3072 nt lds
s_addk_i32 m0, 4096
s_waitcnt vmcnt(20)
buffer_load_dwordx4 v24, s[48:51], s54 offen offset:0 nt lds
buffer_load_dwordx4 v25, s[48:51], s54 offen offset:1024 nt lds
buffer_load_dwordx4 v26, s[48:51], s54 offen offset:2048 nt lds
buffer_load_dwordx4 v27, s[48:51], s54 offen offset:3072 nt lds
s_addk_i32 m0, 4096
s_add_u32 s54, s54, 294912
s_waitcnt lgkmcnt(0)
v_readfirstlane_b32 s31, v41
s_sub_u32 s57, s57, 1
s_cbranch_scc1 L_gue
s_cmp_eq_u32 s31, 0
s_cbranch_scc1 L_gut
L_guu:
buffer_load_dwordx4 v20, s[44:47], s54 offen offset:0 nt lds
buffer_load_dwordx4 v21, s[44:47], s54 offen offset:1024 nt lds
buffer_load_dwordx4 v22, s[44:47], s54 offen offset:2048 nt lds
buffer_load_dwordx4 v23, s[44:47], s54 offen offset:3072 nt lds
s_addk_i32 m0, 4096
    s_nop 0
buffer_load_dwordx4 v24, s[48:51], s54 offen offset:0 nt lds
buffer_load_dwordx4 v25, s[48:51], s54 offen offset:1024 nt lds
buffer_load_dwordx4 v26, s[48:51], s54 offen offset:2048 nt lds
buffer_load_dwordx4 v27, s[48:51], s54 offen offset:3072 nt lds
s_addk_i32 m0, 4096
s_add_u32 s54, s54, 294912
s_sub_u32 s57, s57, 1
s_cbranch_scc0 L_guu
L_gue:
s_mov_b32 m0, 73728
s_mov_b32 s54, 0
L_l_d1:
buffer_load_dwordx4 v16, s[96:99], s54 offen offset:0  lds
buffer_load_dwordx4 v17, s[96:99], s54 offen offset:1024  lds
buffer_load_dwordx4 v18, s[96:99], s54 offen offset:2048  lds
buffer_load_dwordx4 v19, s[96:99], s54 offen offset:3072  lds
s_addk_i32 m0, 4096
s_add_u32 s54, s54, 128
s_cmpk_lt_u32 s54, 1152
s_cbranch_scc1 L_l_d1
L_l_e:
s_branch L_F
L_l_nF:
s_cmp_eq_u32 s56, 1
s_cbranch_scc0 L_l_R
s_mov_b32 m0, 0
s_mov_b32 s54, 0
s_movk_i32 s57, 9
s_cmp_lg_u32 s31, 0
s_cbranch_scc1 L_wou
L_wot:
s_waitcnt vmcnt(20)
ds_read_b32 v41, v6 offset:24
buffer_load_dwordx4 v16, s[96:99], s54 offen offset:0 nt lds
buffer_load_dwordx4 v17, s[96:99], s54 offen offset:1024 nt lds
buffer_load_dwordx4 v18, s[96:99], s54 offen offset:2048 nt lds
buffer_load_dwordx4 v19, s[96:99], s54 offen offset:3072 nt lds
s_addk_i32 m0, 4096
s_add_u32 s54, s54, 36864
s_waitcnt lgkmcnt(0)
v_readfirstlane_b32 s31, v41
s_sub_u32 s57, s57, 1
s_cbranch_scc1 L_woe
s_cmp_eq_u32 s31, 0
s_cbranch_scc1 L_wot
L_wou:
buffer_load_dwordx4 v16, s[96:99], s54 offen offset:0 nt lds
buffer_load_dwordx4 v17, s[96:99], s54 offen offset:1024 nt lds
buffer_load_dwordx4 v18, s[96:99], s54 offen offset:2048 nt lds
buffer_load_dwordx4 v19, s[96:99], s54 offen offset:3072 nt lds
s_addk_i32 m0, 4096
s_add_u32 s54, s54, 36864
s_sub_u32 s57, s57, 1
s_cbranch_scc0 L_wou
L_woe:
s_waitcnt vmcnt(16)
s_barrier
s_barrier
s_movk_i32 s57, 5
L_wo2:
buffer_load_dwordx4 v16, s[96:99], s54 offen offset:0 nt lds
buffer_load_dwordx4 v17, s[96:99], s54 offen offset:1024 nt lds
buffer_load_dwordx4 v18, s[96:99], s54 offen offset:2048 nt lds
buffer_load_dwordx4 v19, s[96:99], s54 offen offset:3072 nt lds
s_addk_i32 m0, 4096
s_add_u32 s54, s54, 36864
s_sub_u32 s57, s57, 1
s_cbranch_scc0 L_wo2
s_waitcnt vmcnt(0)
s_barrier
s_branch L_fin
L_l_R:
L_ls1:
ds_read_b32 v41, v6 offset:24
s_waitcnt lgkmcnt(0)
v_cmp_gt_u32 vcc, 1, v41
s_cbranch_vccz L_ls1k
s_sub_u32 s43, s43, 1
s_cbranch_scc0 L_ls1
s_mov_b32 s43, 0
L_ls1k:
s_branch L_l_h1
L_l_h:
s_cmp_lg_u32 s31, 0
s_cbranch_scc1 L_t1
s_waitcnt vmcnt(2)
L_t1:
ds_read_b32 v41, v6 offset:24
s_cmp_eq_u32 s40, 10
s_cselect_b32 s41, 1, 0
s_and_b32 s58, s39, s41
s_lshr_b32 s41, s39, s41
s_mul_i32 s54, s41, 294912
s_lshl_b32 s58, s58, 10
s_add_u32 s54, s54, s58
s_add_u32 s39, s39, 5
buffer_load_dword v157, v12, s[44:47], s54 offen
buffer_load_dword v156, v12, s[48:51], s54 offen
s_waitcnt lgkmcnt(0)
v_readfirstlane_b32 s31, v41
L_l_h1:
s_cmp_lt_u32 s39, s40
s_cbranch_scc1 L_l_h
L_ls2:
ds_read_b32 v41, v6 offset:24
s_waitcnt lgkmcnt(0)
v_cmp_gt_u32 vcc, 1, v41
s_cbranch_vccz L_ls2k
s_sub_u32 s43, s43, 1
s_cbranch_scc0 L_ls2
s_mov_b32 s43, 0
L_ls2k:
s_sub_u32 s39, s30, 27
L_l_h3:
s_mul_i32 s41, s39, 57
s_lshr_b32 s41, s41, 9
s_mul_i32 s58, s41, 9
s_sub_u32 s58, s39, s58
s_mul_i32 s54, s58, 73728
s_sub_u32 s41, 8, s41
s_lshl_b32 s41, s41, 7
s_add_u32 s54, s54, s41
s_add_u32 s39, s39, 5
buffer_load_dword v157, v14, s[96:99], s54 offen
s_cmp_lt_u32 s39, 81
s_cbranch_scc1 L_l_h3
s_branch L_R
L_att:
s_load_dword s34, s[26:27], 0
v_and_b32 v4, 15, v1
v_mov_b32 v6, 137280
v_mov_b32 v7, 0xff
s_mov_b32 s43, 1048575
s_cmp_lt_u32 s30, 27
s_cselect_b32 s56, 1, 2
s_cmp_lt_u32 s30, 18
s_cselect_b32 s56, 0, s56
s_mul_i32 s52, s29, 18
s_add_u32 s52, s52, s30
s_sub_u32 s53, s30, 18
s_add_u32 s60, s26, 524288
s_addc_u32 s61, s27, 0
s_mov_b64 s[62:63], s[26:27]
v_lshrrev_b32 v80, 3, v4
v_lshlrev_b32 v8, 8, v80
v_lshl_add_u32 v8, v3, 6, v8
v_add_u32 v8, 131392, v8
s_lshl_b32 s41, s38, 10
s_add_u32 s41, s41, 131904
v_lshl_add_u32 v9, v1, 4, s41
s_lshl_b32 s41, s38, 3
s_add_u32 s41, s41, 137344
v_lshl_add_u32 v12, v80, 5, s41
v_lshl_add_u32 v15, s38, 2, v6
v_and_b32 v80, 1, v1
v_lshlrev_b32 v80, 4, v80
v_mov_b32 v81, 0xffff
v_lshlrev_b32 v81, v80, v81
v_bfe_u32 v80, v1, 1, 2
v_cmp_eq_u32 vcc, 0, v80
    s_nop 1
v_cndmask_b32 v104, 0, v81, vcc
v_cmp_eq_u32 vcc, 1, v80
    s_nop 1
v_cndmask_b32 v105, 0, v81, vcc
v_cmp_eq_u32 vcc, 2, v80
    s_nop 1
v_cndmask_b32 v106, 0, v81, vcc
v_cmp_eq_u32 vcc, 3, v80
    s_nop 1
v_cndmask_b32 v107, 0, v81, vcc
s_mov_b32 s44, 0xaaaaaaaa
s_mov_b32 s45, 0xaaaaaaaa
s_mov_b32 s46, 0xcccccccc
s_mov_b32 s47, 0xcccccccc
v_mov_b32 v112, 0x3fb8aa3b
v_mov_b32 v114, 0x3db504f3
s_waitcnt lgkmcnt(0)
s_add_u32 s34, s34, 1
s_and_b32 s35, s34, 0xff
s_mul_i32 s37, s35, 0x01010101
v_mov_b32 v2, s35
s_barrier
s_barrier
v_xor_b32 v122, 6144, v10
global_load_dwordx4 v[40:43], v122, s[6:7] nt
v_xor_b32 v123, 7168, v10
global_load_dwordx4 v[44:47], v123, s[6:7] nt
global_load_dwordx4 v[48:51], v11, s[8:9] nt
s_barrier
v_xor_b32 v121, 1024, v11
global_load_dwordx4 v[52:55], v121, s[8:9] nt
v_xor_b32 v122, 2048, v11
global_load_dwordx4 v[56:59], v122, s[8:9] nt
s_barrier
v_xor_b32 v123, 3072, v11
global_load_dwordx4 v[60:63], v123, s[8:9] nt
v_xor_b32 v120, 4096, v11
global_load_dwordx4 v[64:67], v120, s[8:9] nt
v_xor_b32 v121, 5120, v11
global_load_dwordx4 v[68:71], v121, s[8:9] nt
v_xor_b32 v122, 6144, v11
global_load_dwordx4 v[72:75], v122, s[8:9] nt
v_xor_b32 v123, 7168, v11
global_load_dwordx4 v[76:79], v123, s[8:9] nt
s_barrier
s_waitcnt vmcnt(12)
s_mov_b32 vcc_lo, 0x55555555
s_mov_b32 vcc_hi, 0x55555555
v_cndmask_b32_dpp v80, v20, v16, vcc quad_perm:[1,0,3,2] row_mask:0xf bank_mask:0xf
v_cndmask_b32_dpp v81, v21, v17, vcc quad_perm:[1,0,3,2] row_mask:0xf bank_mask:0xf
v_cndmask_b32_dpp v82, v22, v18, vcc quad_perm:[1,0,3,2] row_mask:0xf bank_mask:0xf
v_cndmask_b32_dpp v83, v23, v19, vcc quad_perm:[1,0,3,2] row_mask:0xf bank_mask:0xf
v_cndmask_b32_dpp v88, v28, v24, vcc quad_perm:[1,0,3,2] row_mask:0xf bank_mask:0xf
v_cndmask_b32_dpp v89, v29, v25, vcc quad_perm:[1,0,3,2] row_mask:0xf bank_mask:0xf
v_cndmask_b32_dpp v90, v30, v26, vcc quad_perm:[1,0,3,2] row_mask:0xf bank_mask:0xf
v_cndmask_b32_dpp v91, v31, v27, vcc quad_perm:[1,0,3,2] row_mask:0xf bank_mask:0xf
s_not_b64 vcc, vcc
v_cndmask_b32_dpp v84, v16, v20, vcc quad_perm:[1,0,3,2] row_mask:0xf bank_mask:0xf
v_cndmask_b32_dpp v85, v17, v21, vcc quad_perm:[1,0,3,2] row_mask:0xf bank_mask:0xf
v_cndmask_b32_dpp v86, v18, v22, vcc quad_perm:[1,0,3,2] row_mask:0xf bank_mask:0xf
v_cndmask_b32_dpp v87, v19, v23, vcc quad_perm:[1,0,3,2] row_mask:0xf bank_mask:0xf
v_cndmask_b32_dpp v92, v24, v28, vcc quad_perm:[1,0,3,2] row_mask:0xf bank_mask:0xf
v_cndmask_b32_dpp v93, v25, v29, vcc quad_perm:[1,0,3,2] row_mask:0xf bank_mask:0xf
v_cndmask_b32_dpp v94, v26, v30, vcc quad_perm:[1,0,3,2] row_mask:0xf bank_mask:0xf
v_cndmask_b32_dpp v95, v27, v31, vcc quad_perm:[1,0,3,2] row_mask:0xf bank_mask:0xf
s_mov_b32 vcc_lo, 0x33333333
s_mov_b32 vcc_hi, 0x33333333
v_cndmask_b32_dpp v16, v88, v80, vcc quad_perm:[2,3,0,1] row_mask:0xf bank_mask:0xf
v_cndmask_b32_dpp v17, v89, v81, vcc quad_perm:[2,3,0,1] row_mask:0xf bank_mask:0xf
v_cndmask_b32_dpp v18, v90, v82, vcc quad_perm:[2,3,0,1] row_mask:0xf bank_mask:0xf
v_cndmask_b32_dpp v19, v91, v83, vcc quad_perm:[2,3,0,1] row_mask:0xf bank_mask:0xf
v_cndmask_b32_dpp v20, v92, v84, vcc quad_perm:[2,3,0,1] row_mask:0xf bank_mask:0xf
v_cndmask_b32_dpp v21, v93, v85, vcc quad_perm:[2,3,0,1] row_mask:0xf bank_mask:0xf
v_cndmask_b32_dpp v22, v94, v86, vcc quad_perm:[2,3,0,1] row_mask:0xf bank_mask:0xf
v_cndmask_b32_dpp v23, v95, v87, vcc quad_perm:[2,3,0,1] row_mask:0xf bank_mask:0xf
s_not_b64 vcc, vcc
v_cndmask_b32_dpp v24, v80, v88, vcc quad_perm:[2,3,0,1] row_mask:0xf bank_mask:0xf
v_cndmask_b32_dpp v25, v81, v89, vcc quad_perm:[2,3,0,1] row_mask:0xf bank_mask:0xf
v_cndmask_b32_dpp v26, v82, v90, vcc quad_perm:[2,3,0,1] row_mask:0xf bank_mask:0xf
v_cndmask_b32_dpp v27, v83, v91, vcc quad_perm:[2,3,0,1] row_mask:0xf bank_mask:0xf
v_cndmask_b32_dpp v28, v84, v92, vcc quad_perm:[2,3,0,1] row_mask:0xf bank_mask:0xf
v_cndmask_b32_dpp v29, v85, v93, vcc quad_perm:[2,3,0,1] row_mask:0xf bank_mask:0xf
v_cndmask_b32_dpp v30, v86, v94, vcc quad_perm:[2,3,0,1] row_mask:0xf bank_mask:0xf
v_cndmask_b32_dpp v31, v87, v95, vcc quad_perm:[2,3,0,1] row_mask:0xf bank_mask:0xf
s_waitcnt vmcnt(8)
s_mov_b32 vcc_lo, 0x55555555
s_mov_b32 vcc_hi, 0x55555555
v_cndmask_b32_dpp v80, v36, v32, vcc quad_perm:[1,0,3,2] row_mask:0xf bank_mask:0xf
v_cndmask_b32_dpp v81, v37, v33, vcc quad_perm:[1,0,3,2] row_mask:0xf bank_mask:0xf
v_cndmask_b32_dpp v82, v38, v34, vcc quad_perm:[1,0,3,2] row_mask:0xf bank_mask:0xf
v_cndmask_b32_dpp v83, v39, v35, vcc quad_perm:[1,0,3,2] row_mask:0xf bank_mask:0xf
v_cndmask_b32_dpp v88, v44, v40, vcc quad_perm:[1,0,3,2] row_mask:0xf bank_mask:0xf
v_cndmask_b32_dpp v89, v45, v41, vcc quad_perm:[1,0,3,2] row_mask:0xf bank_mask:0xf
v_cndmask_b32_dpp v90, v46, v42, vcc quad_perm:[1,0,3,2] row_mask:0xf bank_mask:0xf
v_cndmask_b32_dpp v91, v47, v43, vcc quad_perm:[1,0,3,2] row_mask:0xf bank_mask:0xf
s_not_b64 vcc, vcc
v_cndmask_b32_dpp v84, v32, v36, vcc quad_perm:[1,0,3,2] row_mask:0xf bank_mask:0xf
v_cndmask_b32_dpp v85, v33, v37, vcc quad_perm:[1,0,3,2] row_mask:0xf bank_mask:0xf
v_cndmask_b32_dpp v86, v34, v38, vcc quad_perm:[1,0,3,2] row_mask:0xf bank_mask:0xf
v_cndmask_b32_dpp v87, v35, v39, vcc quad_perm:[1,0,3,2] row_mask:0xf bank_mask:0xf
v_cndmask_b32_dpp v92, v40, v44, vcc quad_perm:[1,0,3,2] row_mask:0xf bank_mask:0xf
v_cndmask_b32_dpp v93, v41, v45, vcc quad_perm:[1,0,3,2] row_mask:0xf bank_mask:0xf
v_cndmask_b32_dpp v94, v42, v46, vcc quad_perm:[1,0,3,2] row_mask:0xf bank_mask:0xf
v_cndmask_b32_dpp v95, v43, v47, vcc quad_perm:[1,0,3,2] row_mask:0xf bank_mask:0xf
s_mov_b32 vcc_lo, 0x33333333
s_mov_b32 vcc_hi, 0x33333333
v_cndmask_b32_dpp v32, v88, v80, vcc quad_perm:[2,3,0,1] row_mask:0xf bank_mask:0xf
v_cndmask_b32_dpp v33, v89, v81, vcc quad_perm:[2,3,0,1] row_mask:0xf bank_mask:0xf
v_cndmask_b32_dpp v34, v90, v82, vcc quad_perm:[2,3,0,1] row_mask:0xf bank_mask:0xf
v_cndmask_b32_dpp v35, v91, v83, vcc quad_perm:[2,3,0,1] row_mask:0xf bank_mask:0xf
v_cndmask_b32_dpp v36, v92, v84, vcc quad_perm:[2,3,0,1] row_mask:0xf bank_mask:0xf
v_cndmask_b32_dpp v37, v93, v85, vcc quad_perm:[2,3,0,1] row_mask:0xf bank_mask:0xf
v_cndmask_b32_dpp v38, v94, v86, vcc quad_perm:[2,3,0,1] row_mask:0xf bank_mask:0xf
v_cndmask_b32_dpp v39, v95, v87, vcc quad_perm:[2,3,0,1] row_mask:0xf bank_mask:0xf
s_not_b64 vcc, vcc
v_cndmask_b32_dpp v40, v80, v88, vcc quad_perm:[2,3,0,1] row_mask:0xf bank_mask:0xf
v_cndmask_b32_dpp v41, v81, v89, vcc quad_perm:[2,3,0,1] row_mask:0xf bank_mask:0xf
v_cndmask_b32_dpp v42, v82, v90, vcc quad_perm:[2,3,0,1] row_mask:0xf bank_mask:0xf
v_cndmask_b32_dpp v43, v83, v91, vcc quad_perm:[2,3,0,1] row_mask:0xf bank_mask:0xf
v_cndmask_b32_dpp v44, v84, v92, vcc quad_perm:[2,3,0,1] row_mask:0xf bank_mask:0xf
v_cndmask_b32_dpp v45, v85, v93, vcc quad_perm:[2,3,0,1] row_mask:0xf bank_mask:0xf
v_cndmask_b32_dpp v46, v86, v94, vcc quad_perm:[2,3,0,1] row_mask:0xf bank_mask:0xf
v_cndmask_b32_dpp v47, v87, v95, vcc quad_perm:[2,3,0,1] row_mask:0xf bank_mask:0xf
v_lshl_add_u32 v118, v5, 2, v6
L_a_q0:
ds_read_b32 v96, v118 offset:32
ds_read_b128 v[80:83], v8 offset:0
ds_read_b128 v[84:87], v8 offset:16
ds_read_b128 v[88:91], v8 offset:32
ds_read_b128 v[92:95], v8 offset:48
s_waitcnt lgkmcnt(4)
v_and_b32 v119, 3, v96
v_cmp_eq_u32 vcc, 0, v119
s_cbranch_vccz L_a_q1
s_sub_u32 s43, s43, 1
s_cbranch_scc0 L_a_q0
s_mov_b32 s43, 0
L_a_q1:
s_waitcnt lgkmcnt(3)
v_mfma_f32_16x16x32_bf16 v[96:99], v[16:19], v[80:83], 0
s_waitcnt lgkmcnt(2)
v_mfma_f32_16x16x32_bf16 v[96:99], v[20:23], v[84:87], v[96:99]
s_waitcnt lgkmcnt(1)
v_mfma_f32_16x16x32_bf16 v[96:99], v[24:27], v[88:91], v[96:99]
s_waitcnt lgkmcnt(0)
v_mfma_f32_16x16x32_bf16 v[96:99], v[28:31], v[92:95], v[96:99]
v_mfma_f32_16x16x32_bf16 v[100:103], v[32:35], v[80:83], 0
v_mfma_f32_16x16x32_bf16 v[100:103], v[36:39], v[84:87], v[100:103]
v_mfma_f32_16x16x32_bf16 v[100:103], v[40:43], v[88:91], v[100:103]
v_mfma_f32_16x16x32_bf16 v[100:103], v[44:47], v[92:95], v[100:103]
    s_nop 3
v_cndmask_b32 v96, v96, v97, s[44:45]
v_cndmask_b32 v98, v98, v99, s[44:45]
v_cndmask_b32 v96, v96, v98, s[46:47]
    s_nop 0
v_cndmask_b32 v100, v100, v101, s[44:45]
v_cndmask_b32 v102, v102, v103, s[44:45]
v_cndmask_b32 v97, v100, v102, s[46:47]
v_cvt_pk_bf16_f32 v98, v96, v97
v_lshlrev_b32 v96, 16, v98
v_and_b32 v97, 0xffff0000, v98
v_pk_mul_f32 v[96:97], v[96:97], v[114:115] op_sel_hi:[1,0]
v_cvt_pk_bf16_f32 v98, v96, v97
v_lshlrev_b32 v96, 16, v98
v_and_b32 v97, 0xffff0000, v98
v_max_f32 v100, v96, v97
    s_nop 1
v_max_f32_dpp v100, v100, v100 quad_perm:[1,0,3,2] row_mask:0xf bank_mask:0xf
    s_nop 1
v_max_f32_dpp v100, v100, v100 quad_perm:[2,3,0,1] row_mask:0xf bank_mask:0xf
v_mov_b32 v99, v100
    s_nop 1
v_permlane16_swap_b32 v100, v99
v_max_f32 v100, v100, v99
v_mov_b32 v99, v100
    s_nop 1
v_permlane32_swap_b32 v100, v99
v_max_f32 v100, v100, v99
v_sub_f32 v96, v96, v100
v_sub_f32 v97, v97, v100
v_pk_mul_f32 v[96:97], v[96:97], v[112:113] op_sel_hi:[1,0]
v_mul_f32 v100, v112, v100
v_exp_f32 v96, v96
v_exp_f32 v97, v97
v_cvt_pk_bf16_f32 v98, v96, v96
v_add_f32 v101, v96, v97
v_cvt_pk_bf16_f32 v99, v97, v97
v_and_b32_dpp v16, v98, v104 quad_perm:[0,0,0,0] row_mask:0xf bank_mask:0xf
v_and_b32_dpp v17, v98, v105 quad_perm:[0,0,0,0] row_mask:0xf bank_mask:0xf
v_add_f32_dpp v101, v101, v101 quad_perm:[1,0,3,2] row_mask:0xf bank_mask:0xf
v_and_b32_dpp v18, v98, v106 quad_perm:[0,0,0,0] row_mask:0xf bank_mask:0xf
v_and_b32_dpp v19, v98, v107 quad_perm:[0,0,0,0] row_mask:0xf bank_mask:0xf
v_add_f32_dpp v101, v101, v101 quad_perm:[2,3,0,1] row_mask:0xf bank_mask:0xf
v_and_b32_dpp v20, v98, v104 quad_perm:[1,1,1,1] row_mask:0xf bank_mask:0xf
v_and_b32_dpp v21, v98, v105 quad_perm:[1,1,1,1] row_mask:0xf bank_mask:0xf
v_permlane16_swap_b32 v101, v102
v_add_f32 v101, v101, v102
v_and_b32_dpp v22, v98, v106 quad_perm:[1,1,1,1] row_mask:0xf bank_mask:0xf
v_and_b32_dpp v23, v98, v107 quad_perm:[1,1,1,1] row_mask:0xf bank_mask:0xf
v_permlane32_swap_b32 v101, v102
v_add_f32 v101, v101, v102
v_and_b32_dpp v24, v98, v104 quad_perm:[2,2,2,2] row_mask:0xf bank_mask:0xf
v_and_b32_dpp v25, v98, v105 quad_perm:[2,2,2,2] row_mask:0xf bank_mask:0xf
s_mov_b64 exec, 0x101
ds_write_b64 v12, v[100:101]
s_mov_b64 exec, -1
v_and_b32_dpp v26, v98, v106 quad_perm:[2,2,2,2] row_mask:0xf bank_mask:0xf
v_and_b32_dpp v27, v98, v107 quad_perm:[2,2,2,2] row_mask:0xf bank_mask:0xf
v_and_b32_dpp v28, v98, v104 quad_perm:[3,3,3,3] row_mask:0xf bank_mask:0xf
v_and_b32_dpp v29, v98, v105 quad_perm:[3,3,3,3] row_mask:0xf bank_mask:0xf
v_and_b32_dpp v30, v98, v106 quad_perm:[3,3,3,3] row_mask:0xf bank_mask:0xf
v_and_b32_dpp v31, v98, v107 quad_perm:[3,3,3,3] row_mask:0xf bank_mask:0xf
s_waitcnt vmcnt(7)
v_mfma_f32_16x16x32_bf16 v[108:111], v[48:51], v[16:19], 0
v_and_b32_dpp v32, v99, v104 quad_perm:[0,0,0,0] row_mask:0xf bank_mask:0xf
v_and_b32_dpp v33, v99, v105 quad_perm:[0,0,0,0] row_mask:0xf bank_mask:0xf
v_and_b32_dpp v34, v99, v106 quad_perm:[0,0,0,0] row_mask:0xf bank_mask:0xf
v_and_b32_dpp v35, v99, v107 quad_perm:[0,0,0,0] row_mask:0xf bank_mask:0xf
s_waitcnt vmcnt(6)
v_mfma_f32_16x16x32_bf16 v[108:111], v[52:55], v[20:23], v[108:111]
v_and_b32_dpp v36, v99, v104 quad_perm:[1,1,1,1] row_mask:0xf bank_mask:0xf
v_and_b32_dpp v37, v99, v105 quad_perm:[1,1,1,1] row_mask:0xf bank_mask:0xf
v_and_b32_dpp v38, v99, v106 quad_perm:[1,1,1,1] row_mask:0xf bank_mask:0xf
v_and_b32_dpp v39, v99, v107 quad_perm:[1,1,1,1] row_mask:0xf bank_mask:0xf
s_waitcnt vmcnt(5)
v_mfma_f32_16x16x32_bf16 v[108:111], v[56:59], v[24:27], v[108:111]
v_and_b32_dpp v40, v99, v104 quad_perm:[2,2,2,2] row_mask:0xf bank_mask:0xf
v_and_b32_dpp v41, v99, v105 quad_perm:[2,2,2,2] row_mask:0xf bank_mask:0xf
v_and_b32_dpp v42, v99, v106 quad_perm:[2,2,2,2] row_mask:0xf bank_mask:0xf
v_and_b32_dpp v43, v99, v107 quad_perm:[2,2,2,2] row_mask:0xf bank_mask:0xf
s_waitcnt vmcnt(4)
v_mfma_f32_16x16x32_bf16 v[108:111], v[60:63], v[28:31], v[108:111]
v_and_b32_dpp v44, v99, v104 quad_perm:[3,3,3,3] row_mask:0xf bank_mask:0xf
v_and_b32_dpp v45, v99, v105 quad_perm:[3,3,3,3] row_mask:0xf bank_mask:0xf
v_and_b32_dpp v46, v99, v106 quad_perm:[3,3,3,3] row_mask:0xf bank_mask:0xf
v_and_b32_dpp v47, v99, v107 quad_perm:[3,3,3,3] row_mask:0xf bank_mask:0xf
s_waitcnt vmcnt(3)
v_mfma_f32_16x16x32_bf16 v[108:111], v[64:67], v[32:35], v[108:111]
s_waitcnt vmcnt(2)
v_mfma_f32_16x16x32_bf16 v[108:111], v[68:71], v[36:39], v[108:111]
s_waitcnt vmcnt(1)
v_mfma_f32_16x16x32_bf16 v[108:111], v[72:75], v[40:43], v[108:111]
s_waitcnt vmcnt(0)
v_mfma_f32_16x16x32_bf16 v[108:111], v[76:79], v[44:47], v[108:111]
    s_nop 7
ds_write_b128 v9, v[108:111]
ds_write_b32 v15, v7 offset:48
L_role:
s_cmp_eq_u32 s56, 0
s_cbranch_scc0 L_notF
s_lshl_b32 s41, s28, 8
s_add_u32 s41, s41, 1048576
v_mul_u32_u24 v8, 2304, v3
v_lshl_add_u32 v8, v4, 4, v8
v_add_u32 v8, s41, v8
v_add_u32 v9, 9216, v8
s_lshl_b32 s41, s28, 7
v_lshlrev_b32 v10, 3, v4
v_lshl_add_u32 v10, v3, 1, v10
v_add_u32 v10, s41, v10
v_add_u32 v11, 110592, v10
ds_read_u16 v11, v11
v_add_u32 v10, 136000, v10
s_branch L_F_n0
L_F:
s_waitcnt lgkmcnt(0)
v_lshlrev_b32 v11, 16, v11
s_barrier
global_load_dwordx4 v[144:147], v8, s[26:27] sc1
global_load_dwordx4 v[148:151], v9, s[26:27] sc1
s_waitcnt vmcnt(38)
ds_write_b32 v6, v7 offset:28
v_lshlrev_b32 v18, 4, v1
v_add_u32 v18, 136000, v18
v_lshlrev_b32 v19, 2, v1
v_add_u32 v19, 137024, v19
v_mov_b32 v108, 0
v_mov_b32 v109, 0x3f803f80
s_waitcnt vmcnt(0)
s_branch L_F_wS
L_F_retryS:
s_wqm_b64 exec, vcc
global_load_dwordx4 v[144:147], v8, s[26:27] sc1
global_load_dwordx4 v[148:151], v9, s[26:27] sc1
s_waitcnt vmcnt(0)
L_F_wS:
v_xor_b32 v144, v2, v144
v_xor_b32 v148, v2, v148
v_or_b32 v152, v144, v148
v_and_b32 v152, v7, v152
v_cmp_ne_u32 vcc, 0, v152
s_cbranch_vccz L_F_okS
s_sub_u32 s43, s43, 1
s_cbranch_scc0 L_F_retryS
s_mov_b32 s43, 0
L_F_okS:
s_mov_b64 exec, -1
v_pk_add_f32 v[144:145], v[144:145], v[148:149]
v_pk_add_f32 v[146:147], v[146:147], v[150:151]
    s_nop 1
v_permlane32_swap_b32 v144, v146
v_permlane32_swap_b32 v145, v147
v_pk_add_f32 v[144:145], v[144:145], v[146:147]
    s_nop 1
v_permlane16_swap_b32 v144, v145
v_add_f32 v144, v144, v145
v_cvt_pk_bf16_f32 v144, v144, v144
v_and_b32 v144, 0xffff0000, v144
v_add_f32 v144, v144, v11
v_cvt_pk_bf16_f32 v144, v144, v144
ds_write_b16 v10, v144
s_waitcnt lgkmcnt(0)
s_barrier
ds_read_b128 v[104:107], v18
s_mov_b32 exec_hi, 0
ds_read_b32 v108, v19
s_mov_b32 exec_hi, -1
s_waitcnt lgkmcnt(0)
v_dot2_f32_bf16 v110, v104, v109, 0
v_dot2_f32_bf16 v111, v104, v104, 0
v_dot2_f32_bf16 v110, v105, v109, v110
v_dot2_f32_bf16 v111, v105, v105, v111
v_dot2_f32_bf16 v110, v106, v109, v110
v_dot2_f32_bf16 v111, v106, v106, v111
v_dot2_f32_bf16 v110, v107, v109, v110
v_dot2_f32_bf16 v111, v107, v107, v111
v_dot2_f32_bf16 v110, v108, v109, v110
v_dot2_f32_bf16 v111, v108, v108, v111
    s_nop 2
v_permlane32_swap_b32 v110, v111
v_add_f32 v110, v110, v111
    s_nop 1
v_add_f32_dpp v110, v110, v110 row_ror:1 row_mask:0xf bank_mask:0xf
    s_nop 1
v_add_f32_dpp v110, v110, v110 row_ror:2 row_mask:0xf bank_mask:0xf
    s_nop 1
v_add_f32_dpp v110, v110, v110 row_ror:4 row_mask:0xf bank_mask:0xf
    s_nop 1
v_add_f32_dpp v110, v110, v110 row_ror:8 row_mask:0xf bank_mask:0xf
    s_nop 1
v_permlane16_swap_b32 v110, v112
v_add_f32 v110, v110, v112
v_mul_f32 v110, 0x3ae38e39, v110
    s_nop 1
v_permlane32_swap_b32 v110, v111
v_fma_f32 v111, -v110, v110, v111
v_max_f32 v111, 0, v111
v_cvt_pk_bf16_f32 v112, v110, v111
v_and_b32 v111, 0xffff0000, v112
v_add_f32 v111, 0x3727c5ac, v111
v_cvt_pk_bf16_f32 v111, v111, v111
v_and_b32 v111, 0xffff0000, v111
v_sqrt_f32 v111, v111
v_lshlrev_b32 v110, 16, v112
v_cvt_pk_bf16_f32 v111, v111, v111
v_and_b32 v111, 0xffff0000, v111
v_rcp_f32 v111, v111
v_xor_b32 v110, 0x80000000, v110
s_mov_b64 exec, 1
ds_write_b64 v6, v[110:111] offset:16
s_branch L_fin
L_F_n0:
s_cmp_ge_u32 s28, 5
s_cbranch_scc0 L_F_G
v_bfe_u32 v13, v1, 2, 3
v_lshrrev_b32 v12, 1, v5
v_lshl_add_u32 v12, s38, 1, v12
v_and_b32 v14, 6, v13
v_xor_b32 v12, v12, v14
v_lshlrev_b32 v12, 4, v12
v_lshl_add_u32 v12, v13, 7, v12
v_and_b32 v14, 1, v1
v_lshl_add_u32 v12, v14, 3, v12
v_lshrrev_b32 v14, 5, v1
v_lshl_add_u32 v12, v14, 11, v12
v_add_u32 v12, 73728, v12
v_lshlrev_b32 v16, 9, v3
v_lshl_add_u32 v16, v4, 4, v16
v_add_u32 v16, 137472, v16
v_lshl_add_u32 v17, v4, 2, s38
v_mul_u32_u24 v17, 9216, v17
v_lshl_add_u32 v17, v3, 4, v17
s_mul_i32 s41, s52, 64
s_add_u32 s41, s41, 1114112
v_add_u32 v17, s41, v17
s_waitcnt lgkmcnt(0)
v_lshlrev_b32 v11, 16, v11
s_barrier
global_load_dwordx4 v[144:147], v8, s[26:27] sc1
global_load_dwordx4 v[148:151], v9, s[26:27] sc1
s_mov_b32 s57, 0
s_waitcnt vmcnt(0)
s_branch L_F_wD
L_F_retryD:
s_wqm_b64 exec, vcc
global_load_dwordx4 v[144:147], v8, s[26:27] sc1
global_load_dwordx4 v[148:151], v9, s[26:27] sc1
s_waitcnt vmcnt(0)
L_F_wD:
v_xor_b32 v144, v2, v144
v_xor_b32 v148, v2, v148
v_or_b32 v152, v144, v148
v_and_b32 v152, v7, v152
v_cmp_ne_u32 vcc, 0, v152
s_cbranch_vccz L_F_okD
s_sub_u32 s43, s43, 1
s_cbranch_scc0 L_F_retryD
s_mov_b32 s43, 0
L_F_okD:
s_mov_b64 exec, -1
v_pk_add_f32 v[144:145], v[144:145], v[148:149]
v_pk_add_f32 v[146:147], v[146:147], v[150:151]
    s_nop 1
v_permlane32_swap_b32 v144, v146
v_permlane32_swap_b32 v145, v147
v_pk_add_f32 v[144:145], v[144:145], v[146:147]
    s_nop 1
v_permlane16_swap_b32 v144, v145
v_add_f32 v144, v144, v145
v_cvt_pk_bf16_f32 v144, v144, v144
v_and_b32 v144, 0xffff0000, v144
v_add_f32 v144, v144, v11
v_cvt_pk_bf16_f32 v144, v144, v144
ds_write_b16 v10, v144
s_waitcnt lgkmcnt(0)
s_barrier
ds_read_b64_tr_b16 v[20:21], v12 offset:0
ds_read_b64_tr_b16 v[22:23], v12 offset:1024
ds_read_b64_tr_b16 v[24:25], v12 offset:4096
ds_read_b64_tr_b16 v[26:27], v12 offset:5120
ds_read_b64_tr_b16 v[28:29], v12 offset:8192
ds_read_b64_tr_b16 v[30:31], v12 offset:9216
ds_read_b64_tr_b16 v[32:33], v12 offset:12288
ds_read_b64_tr_b16 v[34:35], v12 offset:13312
ds_read_b64_tr_b16 v[36:37], v12 offset:16384
ds_read_b64_tr_b16 v[38:39], v12 offset:17408
ds_read_b64_tr_b16 v[40:41], v12 offset:20480
ds_read_b64_tr_b16 v[42:43], v12 offset:21504
ds_read_b64_tr_b16 v[44:45], v12 offset:24576
ds_read_b64_tr_b16 v[46:47], v12 offset:25600
s_waitcnt lgkmcnt(8)
ds_read_b64_tr_b16 v[48:49], v12 offset:28672
ds_read_b64_tr_b16 v[50:51], v12 offset:29696
ds_read_b64_tr_b16 v[52:53], v12 offset:32768
ds_read_b64_tr_b16 v[54:55], v12 offset:33792
s_waitcnt lgkmcnt(4)
s_barrier
ds_read_b128 v[60:63], v16 offset:128
ds_read_b128 v[64:67], v16 offset:112
ds_read_b128 v[68:71], v16 offset:96
ds_read_b128 v[72:75], v16 offset:80
ds_read_b128 v[76:79], v16 offset:64
ds_read_b128 v[80:83], v16 offset:48
ds_read_b128 v[84:87], v16 offset:32
ds_read_b128 v[88:91], v16 offset:16
ds_read_b128 v[92:95], v16 offset:0
s_waitcnt lgkmcnt(8)
v_mfma_f32_16x16x32_bf16 v[100:103], v[20:23], v[60:63], 0
s_waitcnt lgkmcnt(7)
v_mfma_f32_16x16x32_bf16 v[100:103], v[24:27], v[64:67], v[100:103]
s_waitcnt lgkmcnt(6)
v_mfma_f32_16x16x32_bf16 v[100:103], v[28:31], v[68:71], v[100:103]
s_waitcnt lgkmcnt(5)
v_mfma_f32_16x16x32_bf16 v[100:103], v[32:35], v[72:75], v[100:103]
s_waitcnt lgkmcnt(4)
v_mfma_f32_16x16x32_bf16 v[100:103], v[36:39], v[76:79], v[100:103]
s_waitcnt lgkmcnt(3)
v_mfma_f32_16x16x32_bf16 v[100:103], v[40:43], v[80:83], v[100:103]
s_waitcnt lgkmcnt(2)
v_mfma_f32_16x16x32_bf16 v[100:103], v[44:47], v[84:87], v[100:103]
s_waitcnt lgkmcnt(1)
v_mfma_f32_16x16x32_bf16 v[100:103], v[48:51], v[88:91], v[100:103]
s_waitcnt lgkmcnt(0)
v_mfma_f32_16x16x32_bf16 v[100:103], v[52:55], v[92:95], v[100:103]
s_mov_b32 exec_lo, 0x1ff01ff
s_mov_b32 exec_hi, 0x1ff01ff
    s_nop 5
v_bfi_b32 v100, v7, v2, v100
global_store_dwordx4 v17, v[100:103], s[26:27] sc1
s_branch L_fin
L_F_G:
v_cmp_ne_u32 vcc, 2, v119
    s_nop 0
s_cmp_eq_u64 vcc, 0
s_cselect_b32 s59, 1, 0
s_and_b32 s42, s30, 1
s_lshl2_add_u32 s41, s42, s38
v_lshrrev_b32 v16, 1, v5
v_bfe_u32 v19, v1, 2, 3
v_and_b32 v17, 6, v19
v_xor_b32 v17, v17, v16
v_xor_b32 v17, s41, v17
v_lshlrev_b32 v156, 4, v17
v_lshl_add_u32 v156, v19, 7, v156
v_lshl_add_u32 v156, v16, 12, v156
v_lshrrev_b32 v18, 5, v1
v_lshl_add_u32 v156, v18, 11, v156
v_and_b32 v16, 1, v1
v_lshl_add_u32 v156, v16, 3, v156
v_add_u32 v157, 32768, v156
v_xor_b32 v12, 64, v156
v_xor_b32 v13, 64, v157
s_mul_i32 s41, s42, 576
s_add_u32 s41, s41, 136000
s_add_u32 s57, s41, 128
s_and_b32 s57, s57, 255
s_add_u32 s57, s57, 139520
v_mov_b32 v16, s41
v_mov_b32 v17, s57
v_cmp_eq_u32 vcc, 1, v4
    s_nop 1
v_cndmask_b32 v14, v16, v17, vcc
v_lshl_add_u32 v14, v3, 4, v14
v_cndmask_b32 v16, 0, 64, vcc
v_lshl_add_u32 v16, v3, 4, v16
s_lshl2_add_u32 s41, s52, s38
s_lshl_b32 s41, s41, 7
s_add_u32 s41, s41, 405504
v_add_u32 v153, s41, v16
v_xor_b32 v158, 512, v153
v_and_b32 v17, 1, v3
s_lshl_b32 s41, s38, 9
s_add_u32 s41, s41, 137600
v_lshlrev_b32 v15, 3, v17
v_lshl_add_u32 v15, v18, 2, v15
v_add_u32 v15, s41, v15
v_mov_b32 v154, 0xbdd2d3e8
v_mov_b32 v155, 0xc0135761
global_load_dwordx4 v[136:139], v153, s[26:27] sc1
s_waitcnt lgkmcnt(0)
v_lshlrev_b32 v11, 16, v11
s_barrier
global_load_dwordx4 v[144:147], v8, s[26:27] sc1
global_load_dwordx4 v[148:151], v9, s[26:27] sc1
L_ls3:
ds_read_b32 v140, v6 offset:28
s_waitcnt lgkmcnt(0)
v_cmp_gt_u32 vcc, 1, v140
s_cbranch_vccz L_ls3k
s_sub_u32 s43, s43, 1
s_cbranch_scc0 L_ls3
s_mov_b32 s43, 0
L_ls3k:
ds_read_b64_tr_b16 v[16:17], v12 offset:0
ds_read_b64_tr_b16 v[18:19], v12 offset:1024
ds_read_b64_tr_b16 v[52:53], v156 offset:0
ds_read_b64_tr_b16 v[54:55], v156 offset:1024
ds_read_b64_tr_b16 v[20:21], v12 offset:8192
ds_read_b64_tr_b16 v[22:23], v12 offset:9216
ds_read_b64_tr_b16 v[56:57], v156 offset:8192
ds_read_b64_tr_b16 v[58:59], v156 offset:9216
ds_read_b64_tr_b16 v[24:25], v12 offset:16384
ds_read_b64_tr_b16 v[26:27], v12 offset:17408
ds_read_b64_tr_b16 v[60:61], v156 offset:16384
ds_read_b64_tr_b16 v[62:63], v156 offset:17408
ds_read_b64_tr_b16 v[28:29], v12 offset:24576
ds_read_b64_tr_b16 v[30:31], v12 offset:25600
s_waitcnt lgkmcnt(6)
ds_read_b64_tr_b16 v[64:65], v156 offset:24576
ds_read_b64_tr_b16 v[66:67], v156 offset:25600
ds_read_b64_tr_b16 v[32:33], v13 offset:0
ds_read_b64_tr_b16 v[34:35], v13 offset:1024
ds_read_b64_tr_b16 v[68:69], v157 offset:0
ds_read_b64_tr_b16 v[70:71], v157 offset:1024
ds_read_b64_tr_b16 v[36:37], v13 offset:8192
ds_read_b64_tr_b16 v[38:39], v13 offset:9216
s_waitcnt lgkmcnt(6)
ds_read_b64_tr_b16 v[72:73], v157 offset:8192
ds_read_b64_tr_b16 v[74:75], v157 offset:9216
ds_read_b64_tr_b16 v[40:41], v13 offset:16384
ds_read_b64_tr_b16 v[42:43], v13 offset:17408
ds_read_b64_tr_b16 v[76:77], v157 offset:16384
ds_read_b64_tr_b16 v[78:79], v157 offset:17408
ds_read_b64_tr_b16 v[44:45], v13 offset:24576
ds_read_b64_tr_b16 v[46:47], v13 offset:25600
s_waitcnt lgkmcnt(6)
ds_read_b64_tr_b16 v[80:81], v157 offset:24576
ds_read_b64_tr_b16 v[82:83], v157 offset:25600
ds_read_b64_tr_b16 v[48:49], v13 offset:32768
ds_read_b64_tr_b16 v[50:51], v13 offset:33792
ds_read_b64_tr_b16 v[84:85], v157 offset:32768
ds_read_b64_tr_b16 v[86:87], v157 offset:33792
s_waitcnt vmcnt(0)
s_branch L_F_wG
L_F_retryG:
s_wqm_b64 exec, vcc
global_load_dwordx4 v[144:147], v8, s[26:27] sc1
global_load_dwordx4 v[148:151], v9, s[26:27] sc1
s_waitcnt vmcnt(0)
L_F_wG:
v_xor_b32 v144, v2, v144
v_xor_b32 v148, v2, v148
v_or_b32 v152, v144, v148
v_and_b32 v152, v7, v152
v_cmp_ne_u32 vcc, 0, v152
s_cbranch_vccz L_F_okG
s_sub_u32 s43, s43, 1
s_cbranch_scc0 L_F_retryG
s_mov_b32 s43, 0
L_F_okG:
s_mov_b64 exec, -1
v_pk_add_f32 v[144:145], v[144:145], v[148:149]
v_pk_add_f32 v[146:147], v[146:147], v[150:151]
    s_nop 1
v_permlane32_swap_b32 v144, v146
v_permlane32_swap_b32 v145, v147
v_pk_add_f32 v[144:145], v[144:145], v[146:147]
    s_nop 1
v_permlane16_swap_b32 v144, v145
v_add_f32 v144, v144, v145
v_cvt_pk_bf16_f32 v144, v144, v144
v_and_b32 v144, 0xffff0000, v144
v_add_f32 v144, v144, v11
v_cvt_pk_bf16_f32 v144, v144, v144
ds_write_b16 v10, v144
s_waitcnt lgkmcnt(0)
s_barrier
ds_read_b128 v[96:99], v14 offset:0
ds_read_b128 v[100:103], v14 offset:64
ds_read_b128 v[104:107], v14 offset:128
ds_read_b128 v[108:111], v14 offset:192
ds_read_b128 v[112:115], v14 offset:256
ds_read_b128 v[116:119], v14 offset:320
ds_read_b128 v[120:123], v14 offset:384
ds_read_b128 v[124:127], v14 offset:448
ds_read_b128 v[128:131], v14 offset:512
s_waitcnt lgkmcnt(8)
v_mfma_f32_16x16x32_bf16 v[132:135], v[16:19], v[96:99], 0
s_waitcnt lgkmcnt(7)
v_mfma_f32_16x16x32_bf16 v[132:135], v[20:23], v[100:103], v[132:135]
s_waitcnt lgkmcnt(6)
v_mfma_f32_16x16x32_bf16 v[132:135], v[24:27], v[104:107], v[132:135]
s_waitcnt lgkmcnt(5)
v_mfma_f32_16x16x32_bf16 v[132:135], v[28:31], v[108:111], v[132:135]
s_waitcnt lgkmcnt(4)
v_mfma_f32_16x16x32_bf16 v[132:135], v[32:35], v[112:115], v[132:135]
s_waitcnt lgkmcnt(3)
v_mfma_f32_16x16x32_bf16 v[132:135], v[36:39], v[116:119], v[132:135]
s_waitcnt lgkmcnt(2)
v_mfma_f32_16x16x32_bf16 v[132:135], v[40:43], v[120:123], v[132:135]
s_waitcnt lgkmcnt(1)
v_mfma_f32_16x16x32_bf16 v[132:135], v[44:47], v[124:127], v[132:135]
s_waitcnt lgkmcnt(0)
v_mfma_f32_16x16x32_bf16 v[132:135], v[48:51], v[128:131], v[132:135]
v_mfma_f32_16x16x32_bf16 v[92:95], v[52:55], v[96:99], 0
s_mov_b32 exec_lo, 0x30003
s_mov_b32 exec_hi, 0x30003
    s_nop 4
v_bfi_b32 v132, v7, v2, v132
s_cmp_eq_u32 s59, 0
s_cbranch_scc1 L_ms3
global_store_dwordx4 v158, v[132:135], s[26:27]
s_branch L_me3
L_ms3:
global_store_dwordx4 v158, v[132:135], s[26:27] sc1
L_me3:
s_mov_b64 exec, -1
v_mfma_f32_16x16x32_bf16 v[92:95], v[56:59], v[100:103], v[92:95]
v_mfma_f32_16x16x32_bf16 v[92:95], v[60:63], v[104:107], v[92:95]
v_mfma_f32_16x16x32_bf16 v[92:95], v[64:67], v[108:111], v[92:95]
v_mfma_f32_16x16x32_bf16 v[92:95], v[68:71], v[112:115], v[92:95]
v_mfma_f32_16x16x32_bf16 v[92:95], v[72:75], v[116:119], v[92:95]
v_mfma_f32_16x16x32_bf16 v[92:95], v[76:79], v[120:123], v[92:95]
v_mfma_f32_16x16x32_bf16 v[92:95], v[80:83], v[124:127], v[92:95]
v_mfma_f32_16x16x32_bf16 v[92:95], v[84:87], v[128:131], v[92:95]
L_G_x0:
global_load_dwordx4 v[136:139], v153, s[62:63] sc1
ds_read_b64 v[16:17], v6 offset:16
s_waitcnt vmcnt(0)
v_xor_b32 v136, v2, v136
v_and_b32 v140, v7, v136
v_cmp_ne_u32 vcc, 0, v140
s_cbranch_vccz L_G_x1
s_sub_u32 s43, s43, 1
s_cbranch_scc0 L_G_x0
s_mov_b32 s43, 0
L_G_x1:
    s_nop 0
v_pk_add_f32 v[92:93], v[92:93], v[136:137]
v_pk_add_f32 v[94:95], v[94:95], v[138:139]
s_branch L_G_s1
L_G_s0:
ds_read_b64 v[16:17], v6 offset:16
L_G_s1:
s_waitcnt lgkmcnt(0)
v_cmp_eq_u32 vcc, 0, v17
s_cbranch_vccz L_G_s2
s_sub_u32 s43, s43, 1
s_cbranch_scc0 L_G_s0
s_mov_b32 s43, 0
L_G_s2:
v_fmac_f32_dpp v92, v92, v16 quad_perm:[1,1,1,1] row_mask:0xf bank_mask:0xf
v_fmac_f32_dpp v93, v93, v16 quad_perm:[1,1,1,1] row_mask:0xf bank_mask:0xf
v_fmac_f32_dpp v94, v94, v16 quad_perm:[1,1,1,1] row_mask:0xf bank_mask:0xf
v_fmac_f32_dpp v95, v95, v16 quad_perm:[1,1,1,1] row_mask:0xf bank_mask:0xf
v_pk_mul_f32 v[92:93], v[92:93], v[16:17] op_sel:[0,1]
v_pk_mul_f32 v[94:95], v[94:95], v[16:17] op_sel:[0,1]
v_cvt_pk_bf16_f32 v18, v92, v93
v_cvt_pk_bf16_f32 v19, v94, v95
    s_nop 1
v_permlane32_swap_b32 v18, v19
v_lshlrev_b32 v20, 16, v18
v_and_b32 v21, 0xffff0000, v18
v_pk_mul_f32 v[24:25], v[20:21], v[20:21]
v_pk_fma_f32 v[24:25], v[24:25], v[154:155], v[154:155] op_sel:[0,0,1] op_sel_hi:[1,0,1]
v_lshlrev_b32 v22, 16, v19
v_pk_mul_f32 v[24:25], v[24:25], v[20:21]
v_exp_f32 v24, v24
v_exp_f32 v25, v25
v_and_b32 v23, 0xffff0000, v19
v_pk_add_f32 v[24:25], v[24:25], 1.0 op_sel_hi:[1,0]
v_rcp_f32 v24, v24
v_rcp_f32 v25, v25
s_mov_b32 exec_lo, 0x00010001
s_mov_b32 exec_hi, 0x00010001
v_pk_mul_f32 v[20:21], v[20:21], v[24:25]
v_cvt_pk_bf16_f32 v18, v20, v21
v_lshlrev_b32 v20, 16, v18
v_and_b32 v21, 0xffff0000, v18
v_pk_mul_f32 v[20:21], v[20:21], v[22:23]
v_cvt_pk_bf16_f32 v18, v20, v21
ds_write_b32 v15, v18
s_waitcnt lgkmcnt(0)
s_barrier
s_branch L_fin
L_notF:
s_cmp_eq_u32 s56, 1
s_cbranch_scc0 L_R
v_bfe_u32 v12, v1, 2, 3
v_lshrrev_b32 v14, 1, v5
v_lshl_add_u32 v14, s38, 1, v14
v_and_b32 v13, 6, v12
v_xor_b32 v14, v14, v13
v_lshlrev_b32 v14, 4, v14
v_lshl_add_u32 v14, v12, 7, v14
v_and_b32 v13, 1, v1
v_lshl_add_u32 v14, v13, 3, v14
v_lshrrev_b32 v13, 5, v1
v_lshl_add_u32 v14, v13, 11, v14
s_lshl_b32 s41, s29, 15
s_lshr_b32 s42, s55, 2
s_lshl_b32 s42, s42, 14
s_add_u32 s41, s41, s42
s_lshl_b32 s42, s38, 8
s_add_u32 s41, s41, s42
s_add_u32 s41, s41, 139264
v_lshl_add_u32 v10, v3, 2, v5
v_bfe_u32 v8, v1, 2, 2
v_lshlrev_b32 v8, 12, v8
v_lshl_add_u32 v8, v10, 4, v8
v_add_u32 v8, s41, v8
s_lshr_b32 s42, s55, 1
s_lshl2_add_u32 s41, s29, s42
s_lshl_b32 s41, s41, 7
s_add_u32 s41, s41, 401408
v_lshl_add_u32 v11, v4, 3, s41
s_lshl_b32 s41, s55, 7
s_add_u32 s41, s41, 136000
v_lshl_add_u32 v10, v10, 3, s41
v_lshlrev_b32 v12, 4, v3
s_mul_i32 s41, s29, 2304
s_lshl_b32 s42, s53, 8
s_add_u32 s41, s41, s42
s_add_u32 s41, s41, 1048576
v_lshl_add_u32 v15, v4, 4, s41
s_lshl_b32 s41, s38, 6
s_add_u32 s41, s41, 131904
v_add_u32 v13, s41, v12
v_lshl_add_u32 v9, s38, 2, v6
v_add_u32 v12, 136000, v12
s_mov_b32 s42, 0
s_mov_b32 s57, 0
s_mov_b32 s58, 0
s_mov_b64 s[46:47], -1
s_cmp_ge_u32 s55, 4
s_barrier
global_load_dwordx2 v[148:149], v11, s[62:63] sc1
global_load_dwordx4 v[128:131], v8, s[62:63] offset:0 sc1
global_load_dwordx4 v[132:135], v8, s[62:63] offset:1024 sc1
global_load_dwordx4 v[136:139], v8, s[62:63] offset:2048 sc1
global_load_dwordx4 v[140:143], v8, s[62:63] offset:3072 sc1
s_barrier
s_cbranch_scc1 L_O_chk
ds_read_b64_tr_b16 v[16:17], v14 offset:0
ds_read_b64_tr_b16 v[18:19], v14 offset:1024
ds_read_b64_tr_b16 v[20:21], v14 offset:4096
ds_read_b64_tr_b16 v[22:23], v14 offset:5120
ds_read_b64_tr_b16 v[24:25], v14 offset:8192
ds_read_b64_tr_b16 v[26:27], v14 offset:9216
ds_read_b64_tr_b16 v[28:29], v14 offset:12288
ds_read_b64_tr_b16 v[30:31], v14 offset:13312
ds_read_b64_tr_b16 v[32:33], v14 offset:16384
ds_read_b64_tr_b16 v[34:35], v14 offset:17408
ds_read_b64_tr_b16 v[36:37], v14 offset:20480
ds_read_b64_tr_b16 v[38:39], v14 offset:21504
L_O_chk:
s_cmp_lg_u32 s42, 0
s_cbranch_scc1 L_O_c1
s_mov_b64 exec, -1
s_waitcnt vmcnt(4)
v_cmp_ne_u32 vcc, s37, v149
s_cbranch_vccnz L_O_c0
v_max_f32_dpp v150, v148, v148 row_ror:1 row_mask:0xf bank_mask:0xf
    s_nop 1
v_max_f32_dpp v150, v150, v150 row_ror:2 row_mask:0xf bank_mask:0xf
    s_nop 1
v_max_f32_dpp v150, v150, v150 row_ror:4 row_mask:0xf bank_mask:0xf
    s_nop 1
v_max_f32_dpp v150, v150, v150 row_ror:8 row_mask:0xf bank_mask:0xf
v_sub_f32 v150, v148, v150
v_exp_f32 v150, v150
s_mov_b32 s42, 1
    s_nop 0
v_add_f32_dpp v151, v150, v150 row_ror:1 row_mask:0xf bank_mask:0xf
    s_nop 1
v_add_f32_dpp v151, v151, v151 row_ror:2 row_mask:0xf bank_mask:0xf
    s_nop 1
v_add_f32_dpp v151, v151, v151 row_ror:4 row_mask:0xf bank_mask:0xf
    s_nop 1
v_add_f32_dpp v151, v151, v151 row_ror:8 row_mask:0xf bank_mask:0xf
v_rcp_f32 v151, v151
    s_nop 0
v_mul_f32 v150, v150, v151
    s_nop 1
v_mov_b32_dpp v152, v150 quad_perm:[0,0,0,0] row_mask:0xf bank_mask:0xf
v_mov_b32_dpp v153, v150 quad_perm:[1,1,1,1] row_mask:0xf bank_mask:0xf
v_mov_b32_dpp v154, v150 quad_perm:[2,2,2,2] row_mask:0xf bank_mask:0xf
v_mov_b32_dpp v155, v150 quad_perm:[3,3,3,3] row_mask:0xf bank_mask:0xf
L_O_c0:
s_mov_b64 exec, s[46:47]
L_O_c1:
s_waitcnt vmcnt(0)
v_xor_b32 v128, v2, v128
v_xor_b32 v132, v2, v132
v_xor_b32 v136, v2, v136
v_xor_b32 v140, v2, v140
v_or3_b32 v151, v128, v132, v136
v_or_b32 v151, v151, v140
v_and_b32 v151, v7, v151
v_cmp_ne_u32 vcc, 0, v151
    s_nop 0
s_wqm_b64 s[46:47], vcc
s_cbranch_scc1 L_O_re
s_mov_b64 s[46:47], 15
s_cmp_eq_u32 s42, 0
s_cbranch_scc1 L_O_re
L_O_cmp:
s_mov_b64 exec, -1
v_mul_f32 v144, v152, v128
v_mul_f32 v145, v152, v129
v_mul_f32 v146, v152, v130
v_mul_f32 v147, v152, v131
v_fmac_f32 v144, v153, v132
v_fmac_f32 v145, v153, v133
v_fmac_f32 v146, v153, v134
v_fmac_f32 v147, v153, v135
v_fmac_f32 v144, v154, v136
v_fmac_f32 v145, v154, v137
v_fmac_f32 v146, v154, v138
v_fmac_f32 v147, v154, v139
v_fmac_f32 v144, v155, v140
v_fmac_f32 v145, v155, v141
v_fmac_f32 v146, v155, v142
v_fmac_f32 v147, v155, v143
v_add_f32_dpp v144, v144, v144 row_ror:4 row_mask:0xf bank_mask:0xf
v_add_f32_dpp v145, v145, v145 row_ror:4 row_mask:0xf bank_mask:0xf
v_add_f32_dpp v146, v146, v146 row_ror:4 row_mask:0xf bank_mask:0xf
v_add_f32_dpp v147, v147, v147 row_ror:4 row_mask:0xf bank_mask:0xf
v_add_f32_dpp v144, v144, v144 row_ror:8 row_mask:0xf bank_mask:0xf
v_add_f32_dpp v145, v145, v145 row_ror:8 row_mask:0xf bank_mask:0xf
v_add_f32_dpp v146, v146, v146 row_ror:8 row_mask:0xf bank_mask:0xf
v_add_f32_dpp v147, v147, v147 row_ror:8 row_mask:0xf bank_mask:0xf
v_cvt_pk_bf16_f32 v144, v144, v145
v_cvt_pk_bf16_f32 v145, v146, v147
ds_write_b64 v10, v[144:145]
s_cmp_lg_u32 s58, 0
s_cbranch_scc1 L_O_dn
s_mov_b32 s57, 1
s_branch L_O_ph
L_O_re:
s_sub_u32 s43, s43, 1
s_cbranch_scc0 L_O_r1
s_mov_b32 s43, 0
s_branch L_O_cmp
L_O_r1:
s_mov_b64 exec, -1
global_load_dwordx2 v[148:149], v11, s[62:63] sc1
s_mov_b64 exec, s[46:47]
global_load_dwordx4 v[128:131], v8, s[62:63] offset:0 sc1
global_load_dwordx4 v[132:135], v8, s[62:63] offset:1024 sc1
global_load_dwordx4 v[136:139], v8, s[62:63] offset:2048 sc1
global_load_dwordx4 v[140:143], v8, s[62:63] offset:3072 sc1
s_cmp_lg_u32 s58, 0
s_cbranch_scc1 L_O_chk
L_O_ph:
s_mov_b32 s58, 1
s_mov_b64 exec, -1
s_cmp_ge_u32 s55, 4
s_waitcnt lgkmcnt(0)
s_barrier
s_cbranch_scc1 L_O_p2
ds_read_b64_tr_b16 v[40:41], v14 offset:24576
ds_read_b64_tr_b16 v[42:43], v14 offset:25600
ds_read_b64_tr_b16 v[44:45], v14 offset:28672
ds_read_b64_tr_b16 v[46:47], v14 offset:29696
ds_read_b64_tr_b16 v[48:49], v14 offset:32768
ds_read_b64_tr_b16 v[50:51], v14 offset:33792
ds_read_b64_tr_b16 v[52:53], v14 offset:36864
ds_read_b64_tr_b16 v[54:55], v14 offset:37888
ds_read_b64_tr_b16 v[56:57], v14 offset:40960
ds_read_b64_tr_b16 v[58:59], v14 offset:41984
ds_read_b64_tr_b16 v[60:61], v14 offset:45056
ds_read_b64_tr_b16 v[62:63], v14 offset:46080
ds_read_b64_tr_b16 v[64:65], v14 offset:49152
ds_read_b64_tr_b16 v[66:67], v14 offset:50176
s_waitcnt lgkmcnt(6)
ds_read_b64_tr_b16 v[68:69], v14 offset:53248
ds_read_b64_tr_b16 v[70:71], v14 offset:54272
ds_read_b64_tr_b16 v[72:73], v14 offset:57344
ds_read_b64_tr_b16 v[74:75], v14 offset:58368
ds_read_b64_tr_b16 v[76:77], v14 offset:61440
ds_read_b64_tr_b16 v[78:79], v14 offset:62464
L_O_p2:
s_cmp_lg_u32 s57, 0
s_cbranch_scc1 L_O_dn
s_mov_b64 exec, s[46:47]
s_branch L_O_chk
L_O_dn:
s_cmp_ge_u32 s55, 4
s_waitcnt lgkmcnt(0)
s_barrier
s_cbranch_scc1 L_O_e
ds_read_b128 v[80:83], v12 offset:0
ds_read_b128 v[84:87], v12 offset:64
ds_read_b128 v[88:91], v12 offset:128
ds_read_b128 v[92:95], v12 offset:192
ds_read_b128 v[96:99], v12 offset:256
ds_read_b128 v[100:103], v12 offset:320
ds_read_b128 v[104:107], v12 offset:384
ds_read_b128 v[108:111], v12 offset:448
s_waitcnt lgkmcnt(7)
v_mfma_f32_16x16x32_bf16 v[128:131], v[16:19], v[80:83], 0
ds_read_b128 v[112:115], v12 offset:512
s_waitcnt lgkmcnt(7)
v_mfma_f32_16x16x32_bf16 v[128:131], v[20:23], v[84:87], v[128:131]
ds_read_b128 v[116:119], v12 offset:576
s_waitcnt lgkmcnt(7)
v_mfma_f32_16x16x32_bf16 v[128:131], v[24:27], v[88:91], v[128:131]
ds_read_b128 v[120:123], v12 offset:640
s_waitcnt lgkmcnt(7)
v_mfma_f32_16x16x32_bf16 v[128:131], v[28:31], v[92:95], v[128:131]
ds_read_b128 v[124:127], v12 offset:704
s_waitcnt lgkmcnt(7)
v_mfma_f32_16x16x32_bf16 v[128:131], v[32:35], v[96:99], v[128:131]
ds_read_b128 v[80:83], v12 offset:768
s_waitcnt lgkmcnt(7)
v_mfma_f32_16x16x32_bf16 v[128:131], v[36:39], v[100:103], v[128:131]
ds_read_b128 v[84:87], v12 offset:832
s_waitcnt lgkmcnt(7)
v_mfma_f32_16x16x32_bf16 v[128:131], v[40:43], v[104:107], v[128:131]
ds_read_b128 v[88:91], v12 offset:896
s_waitcnt lgkmcnt(7)
v_mfma_f32_16x16x32_bf16 v[128:131], v[44:47], v[108:111], v[128:131]
ds_read_b128 v[92:95], v12 offset:960
s_waitcnt lgkmcnt(7)
v_mfma_f32_16x16x32_bf16 v[128:131], v[48:51], v[112:115], v[128:131]
s_waitcnt lgkmcnt(6)
v_mfma_f32_16x16x32_bf16 v[128:131], v[52:55], v[116:119], v[128:131]
s_waitcnt lgkmcnt(5)
v_mfma_f32_16x16x32_bf16 v[128:131], v[56:59], v[120:123], v[128:131]
s_waitcnt lgkmcnt(4)
v_mfma_f32_16x16x32_bf16 v[128:131], v[60:63], v[124:127], v[128:131]
s_waitcnt lgkmcnt(3)
v_mfma_f32_16x16x32_bf16 v[128:131], v[64:67], v[80:83], v[128:131]
s_waitcnt lgkmcnt(2)
v_mfma_f32_16x16x32_bf16 v[128:131], v[68:71], v[84:87], v[128:131]
s_waitcnt lgkmcnt(1)
v_mfma_f32_16x16x32_bf16 v[128:131], v[72:75], v[88:91], v[128:131]
s_waitcnt lgkmcnt(0)
v_mfma_f32_16x16x32_bf16 v[128:131], v[76:79], v[92:95], v[128:131]
s_mov_b32 exec_lo, 0x10001
s_mov_b32 exec_hi, 0x10001
    s_nop 5
ds_write_b128 v13, v[128:131]
ds_write_b32 v9, v7
s_branch L_fin
L_O_e:
s_cmp_eq_u32 s28, 5
s_cbranch_scc0 L_fin
v_lshl_add_u32 v9, v5, 2, v6
v_lshlrev_b32 v13, 4, v4
v_add_u32 v13, 131904, v13
s_xor_b32 s41, s29, 0
s_mul_i32 s41, s41, 9
s_add_u32 s41, s41, s53
s_mul_i32 s41, s41, 73728
v_mul_u32_u24 v44, 1152, v1
v_add_u32 v44, s41, v44
s_mov_b64 exec, 0xffff
L_O_b0:
ds_read_b32 v41, v9
ds_read_b128 v[16:19], v13
s_waitcnt lgkmcnt(1)
v_cmp_eq_u32 vcc, 0, v41
s_cbranch_vccz L_O_b1
s_sub_u32 s43, s43, 1
s_cbranch_scc0 L_O_b0
s_mov_b32 s43, 0
L_O_b1:
s_waitcnt lgkmcnt(0)
v_bfi_b32 v16, v7, v2, v16
global_store_dwordx4 v15, v[16:19], s[26:27] sc1
s_mov_b64 exec, -1
global_load_dword v150, v44, s[20:21] offset:384
global_load_dword v150, v44, s[20:21] offset:256
global_load_dword v150, v44, s[20:21] offset:128
global_load_dword v150, v44, s[20:21] offset:0
s_branch L_fin
L_R:
s_sub_u32 s41, s30, 27
s_lshl3_add_u32 s53, s41, s29
s_cmp_ge_u32 s53, 36
s_cbranch_scc1 L_fin
s_mul_i32 s41, s53, 9216
s_mul_i32 s42, s28, 1024
s_add_u32 s41, s41, s42
s_add_u32 s41, s41, 1114112
v_lshl_add_u32 v10, v5, 2, v3
v_mul_u32_u24 v11, 48, v10
v_add_u32 v11, 136000, v11
v_lshrrev_b32 v9, 3, v1
v_mul_u32_u24 v8, 64, v9
v_and_b32 v9, 7, v1
v_lshl_add_u32 v8, v9, 3, v8
v_add_u32 v8, s41, v8
v_lshrrev_b32 v12, 5, v1
v_lshl_add_u32 v12, v9, 1, v12
v_mul_u32_u24 v12, 48, v12
s_lshl_b32 s41, s28, 2
s_add_u32 s41, s41, 136000
v_add_u32 v12, s41, v12
v_and_b32 v14, 1, v1
v_add_u32 v14, -1, v14
v_and_b32 v15, v7, v14
v_and_b32 v14, v2, v14
v_mov_b32 v16, 0
v_mov_b32 v17, 0
v_lshrrev_b32 v9, 2, v1
s_cmp_eq_u32 s28, 0
s_cbranch_scc0 L_R_p
s_lshl_b32 s41, s53, 5
v_lshl_add_u32 v10, v10, 1, s41

v_add_u32 v13, 110592, v10
ds_read_u16 v13, v13
s_lshl_b32 s41, s53, 6
s_add_u32 s41, s41, 1048576
v_and_b32 v9, 7, v9
v_mul_u32_u24 v9, 2304, v9
v_lshl_add_u32 v9, v5, 4, v9
v_add_u32 v9, s41, v9
v_mov_b32 v32, 0
v_mov_b32 v33, 0
v_mov_b32 v34, 0
v_mov_b32 v35, 0
s_mov_b32 exec_hi, 0
L_R_retry1:
global_load_dwordx4 v[32:35], v9, s[26:27] sc1
s_waitcnt vmcnt(0)
v_xor_b32 v32, v2, v32
v_and_b32 v20, v7, v32
v_cmp_ne_u32 vcc, 0, v20
s_cbranch_vccz L_R_ok1
s_sub_u32 s43, s43, 1
s_cbranch_scc0 L_R_retry1
s_mov_b32 s43, 0
L_R_ok1:
s_mov_b64 exec, -1
v_permlane32_swap_b32 v32, v34
v_permlane32_swap_b32 v33, v35
v_pk_add_f32 v[32:33], v[32:33], v[34:35]
    s_nop 1
v_permlane16_swap_b32 v32, v33
v_add_f32 v32, v32, v33
    s_nop 1
v_add_f32_dpp v32, v32, v32 row_ror:4 row_mask:0xf bank_mask:0xf
    s_nop 1
v_add_f32_dpp v32, v32, v32 row_ror:8 row_mask:0xf bank_mask:0xf
v_cvt_pk_bf16_f32 v32, v32, v32
v_and_b32 v32, 0xffff0000, v32
s_waitcnt lgkmcnt(0)
v_lshlrev_b32 v13, 16, v13
v_add_f32 v32, v32, v13
v_cvt_pk_bf16_f32 v32, v32, v32
v_and_b32 v32, 0xffff0000, v32
L_R_p:
s_barrier
L_R_retry2:
global_atomic_add_x2 v[20:21], v8, v[16:17], s[26:27] offset:0 sc0 sc1
global_atomic_add_x2 v[22:23], v8, v[16:17], s[26:27] offset:512 sc0 sc1
s_waitcnt vmcnt(0)
v_xor_b32 v20, v14, v20
v_xor_b32 v22, v14, v22
v_or_b32 v24, v20, v22
v_and_b32 v24, v15, v24
v_cmp_ne_u32 vcc, 0, v24
v_pk_add_f32 v[20:21], v[20:21], v[22:23]
s_cbranch_vccz L_R_ok2
s_sub_u32 s43, s43, 1
s_cbranch_scc0 L_R_retry2
s_mov_b32 s43, 0
L_R_ok2:
    s_nop 0
v_permlane32_swap_b32 v20, v21
v_add_f32 v20, v20, v21
s_cmp_eq_u32 s28, 0
    s_nop 0
v_add_f32_dpp v20, v20, v20 row_ror:8 row_mask:0xf bank_mask:0xf
    s_nop 1
v_permlane16_swap_b32 v20, v21
s_mov_b32 exec_lo, 0xff
s_mov_b32 exec_hi, 0xff
v_add_f32 v20, v20, v21
ds_write_b32 v12, v20
s_mov_b64 exec, -1
s_waitcnt lgkmcnt(0)
s_barrier
s_cbranch_scc0 L_fin
ds_read_b128 v[20:23], v11
ds_read_b128 v[24:27], v11 offset:16
ds_read_b32 v28, v11 offset:32
s_mov_b32 exec_lo, 0xf000f
s_mov_b32 exec_hi, 0xf000f
s_waitcnt lgkmcnt(1)
v_pk_add_f32 v[20:21], v[20:21], v[24:25]
v_pk_add_f32 v[22:23], v[22:23], v[26:27]
v_pk_add_f32 v[20:21], v[20:21], v[22:23]
s_waitcnt lgkmcnt(0)
v_add_f32 v20, v20, v28
v_add_f32 v20, v20, v21
v_cvt_pk_bf16_f32 v20, v20, v20
v_and_b32 v20, 0xffff0000, v20
v_add_f32 v20, v20, v32
v_cvt_pk_bf16_f32 v20, v20, v20
global_store_short v10, v20, s[22:23]
s_cmp_eq_u32 s53, 0
s_cbranch_scc0 L_fin
s_mov_b64 exec, 1
v_mov_b32 v8, 0
v_mov_b32 v9, s34
global_store_dword v8, v9, s[26:27]
L_fin:
L_end:
s_endpgm
L_code_end:

.section .rodata,"a"
.p2align 6
.amdhsa_kernel sequential_preLN__sliding_block_cached__glu_gated_geglu__decode_kernel
  .amdhsa_next_free_vgpr 160
  .amdhsa_next_free_sgpr 100
  .amdhsa_accum_offset 160
  .amdhsa_group_segment_fixed_size 0
  .amdhsa_kernarg_size 96
  .amdhsa_user_sgpr_count 2
  .amdhsa_user_sgpr_kernarg_segment_ptr 1
  .amdhsa_system_sgpr_workgroup_id_x 1
.end_amdhsa_kernel
```
